```python
import torch

def _softmax(x, axis=-1):
    return torch.softmax(x, dim=axis)

def _gelu(x):
    return torch.nn.functional.gelu(x, approximate='tanh')

def _silu(x):
    return torch.nn.functional.silu(x)

def _sigmoid(x):
    return torch.sigmoid(x)

def _layernorm(x, axis=-1, eps=1e-05):
    m = x.mean(dim=axis, keepdim=True)
    v = x.var(dim=axis, keepdim=True, unbiased=False)
    return (x - m) / torch.sqrt(v + eps)

def _scatter_add(tgt, idx, src, axis=0):
    return tgt.clone().index_add_(axis, idx, src)

def _segment_sum(src, seg, n):
    out = torch.zeros((n,) + src.shape[1:], dtype=src.dtype)
    return out.index_add_(0, seg, src)

def _pad(x, pw):
    flat = tuple((v for pair in reversed(pw) for v in pair))
    return torch.nn.functional.pad(x, flat)
kernel_name = 'parallel_sum__memory_aug_recurrent_mem_tr__dense_activation_silu__prompt'

def setup_inputs():

    _w = lambda a: (lambda t: t.to(torch.bfloat16) if t.is_floating_point() else t)(torch.as_tensor(a))

    def _A_setup():
        B, S, Dm = (1, 2048, 640)
        H, Dh = (32, 192)
        M, seg = (8, 32)
        seg = min(seg, S)
        S = S // seg * seg
        return {'x': _w((lambda *s: torch.randn(*s, dtype=torch.bfloat16) * 0.05)(B, S, Dm)), 'mem0': _w((lambda *s: torch.randn(*s, dtype=torch.bfloat16) * 0.2)(B, M, Dm)), 'Wq': _w((lambda *s: torch.randn(*s, dtype=torch.bfloat16) * 1.6)(Dm, H, Dh) * Dm ** (-0.5)), 'Wk': _w((lambda *s: torch.randn(*s, dtype=torch.bfloat16) * 1.6)(Dm, H, Dh) * Dm ** (-0.5)), 'Wv': _w((lambda *s: torch.randn(*s, dtype=torch.bfloat16) * 0.2)(Dm, H, Dh) * Dm ** (-0.5)), 'Wo': _w((lambda *s: torch.randn(*s, dtype=torch.bfloat16) * 0.2)(H, Dh, Dm) * (H * Dh) ** (-0.5)), 'seg_len': seg}
    _A_in = _A_setup()

    def _B_setup():
        B, S, D, F = (1, 2048, 640, 1536)
        return {'x': _w((lambda *s: torch.randn(*s, dtype=torch.bfloat16) * 0.05)(B, S, D)), 'w1': _w((lambda *s: torch.randn(*s, dtype=torch.bfloat16) * 0.8)(D, F) * D ** (-0.5)), 'w2': _w((lambda *s: torch.randn(*s, dtype=torch.bfloat16) * 0.1)(F, D) * F ** (-0.5))}
    _B_in = _B_setup()
    return {'A_x': _A_in['x'], 'A_mem0': _A_in['mem0'], 'A_Wq': _A_in['Wq'], 'A_Wk': _A_in['Wk'], 'A_Wv': _A_in['Wv'], 'A_Wo': _A_in['Wo'], 'A_seg_len': _A_in['seg_len'], 'B_x': _B_in['x'], 'B_w1': _B_in['w1'], 'B_w2': _B_in['w2']}

def reference(A_x, A_mem0, A_Wq, A_Wk, A_Wv, A_Wo, A_seg_len, B_x, B_w1, B_w2):

    def _A_ref(x, mem0, Wq, Wk, Wv, Wo, seg_len):
        B, S, Dm = x.shape
        H, Dh = (Wq.shape[1], Wq.shape[2])
        M = mem0.shape[1]
        scale = Dh ** (-0.5)
        n_seg = S // seg_len
        L = M + seg_len
        idx = torch.arange(L)
        mask = (idx[:, None] < M) | (idx[:, None] >= idx[None, :])
        mem = mem0
        outs = []
        for s in range(n_seg):
            xs = x[:, s * seg_len:(s + 1) * seg_len, :].clone()
            h = torch.concatenate([mem, xs], axis=1)
            q = torch.einsum('btd,dhe->bhte', h, Wq)
            k = torch.einsum('btd,dhe->bhte', h, Wk)
            v = torch.einsum('btd,dhe->bhte', h, Wv)
            scores = torch.einsum('bhqe,bhke->bhqk', q, k) * scale
            scores = torch.where(mask[None, None], scores, -1000000000.0)
            p = _softmax(scores, axis=-1)
            o = torch.einsum('bhqk,bhke->bhqe', p, v)
            o = torch.einsum('bhte,hed->btd', o, Wo)
            mem = o[:, :M, :].clone()
            outs.append(o[:, M:, :])
        return torch.concatenate(outs, axis=1)

    def _B_ref(x, w1, w2):
        h = torch.einsum('bsd,df->bsf', x, w1)
        h = _silu(h)
        out = torch.einsum('bsf,fd->bsd', h, w2)
        return out
    x = A_x
    xn = _layernorm(x, axis=-1)
    return x + _A_ref(xn, A_mem0, A_Wq, A_Wk, A_Wv, A_Wo, A_seg_len) + _B_ref(xn, B_w1, B_w2)
```

```asm
; @launch grid=(256,1,1) block=(512,1,1) lds=163840
.amdgcn_target "amdgcn-amd-amdhsa--gfx950"
.text
.globl parallel_sum__memory_aug_recurrent_mem_tr__dense_activation_silu__prompt_kernel
.p2align 8
.type parallel_sum__memory_aug_recurrent_mem_tr__dense_activation_silu__prompt_kernel,@function
parallel_sum__memory_aug_recurrent_mem_tr__dense_activation_silu__prompt_kernel:
    s_cmp_ge_u32 s2, 256
    s_cbranch_scc1 L_end
    s_load_dwordx16 s[32:47], s[0:1], 0
    s_load_dwordx8 s[48:55], s[0:1], 64
    s_load_dwordx2 s[56:57], s[0:1], 96
    v_lshrrev_b32 v1, 6, v0
    v_and_b32 v0, 63, v0
    v_readfirstlane_b32 s60, v1
    s_getreg_b32 s61, hwreg(HW_REG_XCC_ID, 0, 4)
    s_mov_b32 s65, 0x30000
    s_mov_b32 s63, 0
    s_mov_b32 s70, 0x3dd53b95
    s_and_b32 s66, s60, 3
    s_waitcnt lgkmcnt(0)
    s_mov_b32 s4, s56
    s_and_b32 s5, s57, 0xffff
    s_mov_b32 s6, 268435456
    s_mov_b32 s7, 0x00020000
    s_mov_b32 s8, s54
    s_and_b32 s9, s55, 0xffff
    s_mov_b32 s10, 256
    s_mov_b32 s11, 0x00020000
    s_mov_b32 s12, s32
    s_and_b32 s13, s33, 0xffff
    s_mov_b32 s14, 2621440
    s_mov_b32 s15, 0x00020000
    s_mov_b32 s16, s52
    s_and_b32 s17, s53, 0xffff
    s_mov_b32 s18, 2621440
    s_mov_b32 s19, 0x00020000
    s_mov_b32 s20, s40
    s_and_b32 s21, s41, 0xffff
    s_mov_b32 s22, 7864320
    s_mov_b32 s23, 0x00020000
    s_mov_b32 s24, s42
    s_and_b32 s25, s43, 0xffff
    s_mov_b32 s26, 7864320
    s_mov_b32 s27, 0x00020000
    s_cmp_ge_u32 s2, 248
    s_cbranch_scc1 L_cal
L_cal_done:
    s_mov_b32 s71, 0
    s_mov_b32 s78, s61
    s_and_b32 s61, s61, 7
    s_lshr_b32 s62, s2, 3
    v_mov_b32 v2, 0
    v_mov_b32 v3, 163584
    ds_write_b32 v3, v2 offset:16
    ds_write_b32 v3, v2 offset:48
    s_lshl_b32 s74, s2, 3
    s_add_u32 s74, s74, s60
    s_mul_i32 s74, s74, 1280
    v_lshlrev_b32 v1, 2, v0
    buffer_load_dword v10, v1, s[12:15], s74 offen offset:0
    buffer_load_dword v11, v1, s[12:15], s74 offen offset:256
    buffer_load_dword v12, v1, s[12:15], s74 offen offset:512
    buffer_load_dword v13, v1, s[12:15], s74 offen offset:768
    buffer_load_dword v14, v1, s[12:15], s74 offen offset:1024
    s_cmp_lt_u32 s60, 4
    s_cbranch_scc1 L_ln_go
    s_lshl_b32 s74, s2, 2
    s_add_u32 s74, s74, s66
    s_mul_i32 s74, s74, 2048
    s_add_u32 s74, s74, 4849664
    v_mov_b32 v36, -1
    v_mov_b32 v37, -1
    v_mov_b32 v38, -1
    v_mov_b32 v39, -1
    v_lshlrev_b32 v2, 4, v0
    s_sleep 3
    buffer_store_dwordx4 v[36:39], v2, s[4:7], s74 offen offset:0 sc1
    buffer_store_dwordx4 v[36:39], v2, s[4:7], s74 offen offset:1024 sc1
    s_lshl_b32 s73, s62, 2
    s_add_u32 s73, s73, s66
    v_lshlrev_b32 v3, 7, v0
    s_mul_i32 s74, s61, 983040
    s_mul_i32 s76, s73, 7936
    s_add_u32 s74, s74, s76
    s_mov_b32 exec_hi, 0x3fffffff
    s_mul_i32 s74, s61, 983040
    s_mul_i32 s76, s73, 12288
    s_add_u32 s74, s74, s76
    s_cmp_ge_u32 s62, 20
    s_cselect_b32 s74, 0x40000000, s74
    s_mov_b32 exec_hi, 0xffff
    buffer_load_dword v32, v3, s[24:27], s74 offen nt
    s_add_u32 s74, s74, 6144
    buffer_load_dword v32, v3, s[24:27], s74 offen nt
    s_mov_b64 exec, -1
    s_waitcnt vmcnt(4)
    s_branch L_ln_go2
L_ln_go:
    s_cmp_lt_u32 s62, 20
    s_cbranch_scc1 L_ln_go1
    v_mul_u32_u24 v2, 43, v0
    v_lshrrev_b32 v2, 9, v2
    v_mul_u32_u24 v3, 12, v2
    v_sub_u32 v3, v0, v3
    v_mul_u32_u24 v2, 12288, v2
    v_lshl_add_u32 v2, v3, 7, v2
    s_mul_i32 s75, s61, 1536
    s_lshl_b32 s73, s62, 2
    s_add_u32 s73, s73, s66
    s_sub_u32 s73, s73, 80
    v_lshlrev_b32 v3, 7, v0
    s_mul_i32 s76, s73, 61440
    s_add_u32 s75, s75, s76
    s_mov_b32 s24, s50
    s_and_b32 s25, s51, 0xffff
    s_mov_b32 s26, 1966080
    s_mov_b32 s27, 0x00020000
    s_mul_i32 s74, s61, 245760
    s_mul_i32 s76, s73, 5632
    s_add_u32 s74, s74, s76
    s_sleep 5
    s_mov_b32 exec_hi, 0x0fffffff
    buffer_load_dword v250, v2, s[20:23], s75 offen
    s_mov_b32 exec_hi, 0xfff
    buffer_load_dword v250, v3, s[24:27], s74 offen nt
    s_mov_b32 exec_hi, 0x0fffffff
    s_add_u32 s75, s75, 2703360
    buffer_load_dword v250, v2, s[20:23], s75 offen
    s_add_u32 s75, s75, 2703360
    buffer_load_dword v250, v2, s[20:23], s75 offen
    s_mov_b64 exec, -1
    s_waitcnt vmcnt(4)
    s_branch L_ln_go2
L_ln_go1:
    s_waitcnt vmcnt(0)
L_ln_go2:
    v_lshlrev_b32 v16, 16, v10
    v_and_b32 v17, 0xffff0000, v10
    v_lshlrev_b32 v18, 16, v11
    v_and_b32 v19, 0xffff0000, v11
    v_lshlrev_b32 v20, 16, v12
    v_and_b32 v21, 0xffff0000, v12
    v_lshlrev_b32 v22, 16, v13
    v_and_b32 v23, 0xffff0000, v13
    v_lshlrev_b32 v24, 16, v14
    v_and_b32 v25, 0xffff0000, v14
    v_add_f32 v4, v16, v17
    v_add_f32 v4, v4, v18
    v_add_f32 v4, v4, v19
    v_add_f32 v4, v4, v20
    v_add_f32 v4, v4, v21
    v_add_f32 v4, v4, v22
    v_add_f32 v4, v4, v23
    v_add_f32 v4, v4, v24
    v_add_f32 v4, v4, v25
    s_nop 1
    v_add_f32_dpp v4, v4, v4 row_ror:8 row_mask:0xf bank_mask:0xf
    s_nop 1
    v_add_f32_dpp v4, v4, v4 row_ror:4 row_mask:0xf bank_mask:0xf
    s_nop 1
    v_add_f32_dpp v4, v4, v4 row_ror:2 row_mask:0xf bank_mask:0xf
    s_nop 1
    v_add_f32_dpp v4, v4, v4 row_ror:1 row_mask:0xf bank_mask:0xf
    v_mov_b32 v6, v4
    s_nop 1
    v_permlane16_swap_b32 v4, v6
    v_add_f32 v4, v4, v6
    v_mov_b32 v6, v4
    s_nop 1
    v_permlane32_swap_b32 v4, v6
    v_add_f32 v4, v4, v6
    v_mul_f32 v4, 0x3acccccd, v4
    v_mov_b32 v5, 0
    v_sub_f32 v6, v16, v4
    v_fmac_f32 v5, v6, v6
    v_sub_f32 v6, v17, v4
    v_fmac_f32 v5, v6, v6
    v_sub_f32 v6, v18, v4
    v_fmac_f32 v5, v6, v6
    v_sub_f32 v6, v19, v4
    v_fmac_f32 v5, v6, v6
    v_sub_f32 v6, v20, v4
    v_fmac_f32 v5, v6, v6
    v_sub_f32 v6, v21, v4
    v_fmac_f32 v5, v6, v6
    v_sub_f32 v6, v22, v4
    v_fmac_f32 v5, v6, v6
    v_sub_f32 v6, v23, v4
    v_fmac_f32 v5, v6, v6
    v_sub_f32 v6, v24, v4
    v_fmac_f32 v5, v6, v6
    v_sub_f32 v6, v25, v4
    v_fmac_f32 v5, v6, v6
    s_nop 1
    v_add_f32_dpp v5, v5, v5 row_ror:8 row_mask:0xf bank_mask:0xf
    s_nop 1
    v_add_f32_dpp v5, v5, v5 row_ror:4 row_mask:0xf bank_mask:0xf
    s_nop 1
    v_add_f32_dpp v5, v5, v5 row_ror:2 row_mask:0xf bank_mask:0xf
    s_nop 1
    v_add_f32_dpp v5, v5, v5 row_ror:1 row_mask:0xf bank_mask:0xf
    v_mov_b32 v6, v5
    s_nop 1
    v_permlane16_swap_b32 v5, v6
    v_add_f32 v5, v5, v6
    v_mov_b32 v6, v5
    s_nop 1
    v_permlane32_swap_b32 v5, v6
    v_add_f32 v5, v5, v6
    v_mul_f32 v5, 0x3acccccd, v5
    v_cvt_pk_bf16_f32 v4, v4, v5
    v_and_b32 v5, 0xffff0000, v4
    v_lshlrev_b32 v4, 16, v4
    v_add_f32 v5, 0x3727c5ac, v5
    v_cvt_pk_bf16_f32 v5, v5, v5
    v_and_b32 v5, 0xffff0000, v5
    v_sqrt_f32 v5, v5
    s_nop 0
    v_cvt_pk_bf16_f32 v5, v5, v5
    v_and_b32 v5, 0xffff0000, v5
    v_rcp_f32 v5, v5
    v_lshrrev_b32 v8, 2, v0
    v_lshlrev_b32 v8, 7, v8
    v_and_b32 v9, 3, v0
    v_lshl_add_u32 v8, v9, 2, v8
    s_lshl_b32 s72, s60, 4
    v_add_u32 v8, s72, v8
    v_sub_f32 v6, v16, v4
    v_sub_f32 v7, v17, v4
    v_cvt_pk_bf16_f32 v6, v6, v7
    v_and_b32 v7, 0xffff0000, v6
    v_lshlrev_b32 v6, 16, v6
    v_mul_f32 v6, v6, v5
    v_mul_f32 v7, v7, v5
    v_cvt_pk_bf16_f32 v10, v6, v7
    ds_write_b32 v8, v10 offset:0
    v_sub_f32 v6, v18, v4
    v_sub_f32 v7, v19, v4
    v_cvt_pk_bf16_f32 v6, v6, v7
    v_and_b32 v7, 0xffff0000, v6
    v_lshlrev_b32 v6, 16, v6
    v_mul_f32 v6, v6, v5
    v_mul_f32 v7, v7, v5
    v_cvt_pk_bf16_f32 v11, v6, v7
    ds_write_b32 v8, v11 offset:2048
    v_sub_f32 v6, v20, v4
    v_sub_f32 v7, v21, v4
    v_cvt_pk_bf16_f32 v6, v6, v7
    v_and_b32 v7, 0xffff0000, v6
    v_lshlrev_b32 v6, 16, v6
    v_mul_f32 v6, v6, v5
    v_mul_f32 v7, v7, v5
    v_cvt_pk_bf16_f32 v12, v6, v7
    ds_write_b32 v8, v12 offset:4096
    v_sub_f32 v6, v22, v4
    v_sub_f32 v7, v23, v4
    v_cvt_pk_bf16_f32 v6, v6, v7
    v_and_b32 v7, 0xffff0000, v6
    v_lshlrev_b32 v6, 16, v6
    v_mul_f32 v6, v6, v5
    v_mul_f32 v7, v7, v5
    v_cvt_pk_bf16_f32 v13, v6, v7
    ds_write_b32 v8, v13 offset:6144
    v_sub_f32 v6, v24, v4
    v_sub_f32 v7, v25, v4
    v_cvt_pk_bf16_f32 v6, v6, v7
    v_and_b32 v7, 0xffff0000, v6
    v_lshlrev_b32 v6, 16, v6
    v_mul_f32 v6, v6, v5
    v_mul_f32 v7, v7, v5
    v_cvt_pk_bf16_f32 v14, v6, v7
    ds_write_b32 v8, v14 offset:8192
    s_waitcnt lgkmcnt(0)
    s_barrier
L_dispatch:
    s_mov_b32 s64, 0
    s_cmp_ge_u32 s60, 4
    s_cbranch_scc1 L_aux_pro
    s_cmp_ge_u32 s62, 20
    s_cbranch_scc1 L_SM
    s_branch L_ZM
L_aux_pro:
    s_setprio 3
    v_lshlrev_b32 v1, 4, v0
    s_cmp_lg_u32 s71, 0
    s_cbranch_scc1 L_ln_done
    s_lshl_b32 s72, s66, 10
    v_add_u32 v2, s72, v1
    ds_read_b128 v[12:15], v2 offset:0
    ds_read_b128 v[16:19], v2 offset:4096
    ds_read_b128 v[20:23], v2 offset:8192
    s_lshr_b32 s75, s2, 2
    s_mul_i32 s75, s75, 40960
    s_bfe_u32 s76, s2, 0x10001
    s_lshl_b32 s76, s76, 10
    s_add_u32 s75, s75, s76
    s_and_b32 s76, s2, 1
    s_lshl_b32 s76, s76, 7
    s_add_u32 s75, s75, s76
    s_lshl_b32 s76, s66, 12
    s_add_u32 s75, s75, s76
    v_and_b32 v3, 7, v0
    v_lshlrev_b32 v3, 4, v3
    v_bfe_u32 v4, v0, 3, 2
    v_lshl_add_u32 v3, v4, 8, v3
    v_lshrrev_b32 v4, 5, v0
    v_lshl_add_u32 v3, v4, 11, v3
    s_waitcnt lgkmcnt(0)
    buffer_store_dwordx4 v[12:15], v3, s[4:7], s75 offen sc1
    s_add_u32 s75, s75, 16384
    buffer_store_dwordx4 v[16:19], v3, s[4:7], s75 offen sc1
    s_add_u32 s75, s75, 16384
    s_cmp_ge_u32 s66, 2
    s_cbranch_scc1 L_ln_done
    buffer_store_dwordx4 v[20:23], v3, s[4:7], s75 offen sc1
L_ln_done:
    s_waitcnt vmcnt(0)
    s_cmp_lg_u32 s71, 0
    s_cbranch_scc1 L_no_arrive
    s_mov_b64 exec, 1
    v_mov_b32 v2, 163584
    v_mov_b32 v3, 1
    ds_add_rtn_u32 v4, v2, v3 offset:16
    s_waitcnt lgkmcnt(0)
    v_readfirstlane_b32 s72, v4
    s_nop 0
    s_cmp_lg_u32 s72, 3
    s_cbranch_scc1 L_no_arrive
    s_lshl_b32 s73, 1, s62
    s_cmp_gt_u32 s78, 7
    s_cselect_b32 s73, 0, s73
    v_mov_b32 v2, s73
    v_mov_b32 v3, 0x100
    s_lshl_b32 s72, s61, 5
    buffer_atomic_add_x2 v[2:3], off, s[8:11], s72 offset:8
L_no_arrive:
    s_mov_b64 exec, -1
    s_cmp_lt_u32 s62, 20
    s_cbranch_scc1 L_pf2_done
    v_mul_u32_u24 v2, 43, v0
    v_lshrrev_b32 v2, 9, v2
    v_mul_u32_u24 v3, 12, v2
    v_sub_u32 v3, v0, v3
    v_mul_u32_u24 v2, 12288, v2
    v_lshl_add_u32 v2, v3, 7, v2
    s_mul_i32 s75, s61, 1536
    s_lshl_b32 s73, s62, 2
    s_add_u32 s73, s73, s66
    s_sub_u32 s73, s73, 80
    s_cmp_ge_u32 s73, 44
    s_cselect_b32 s73, 200, s73
    s_mul_i32 s74, s73, 61440
    s_add_u32 s74, s74, s75
    s_mov_b32 s20, s36
    s_and_b32 s21, s37, 0xffff
    s_mov_b32 s22, 7864320
    s_mov_b32 s23, 0x00020000
    s_mov_b32 s24, s38
    s_and_b32 s25, s39, 0xffff
    s_mov_b32 s26, 7864320
    s_mov_b32 s27, 0x00020000
    s_mov_b32 exec_hi, 0x0fffffff
    s_mov_b32 s20, s48
    s_and_b32 s21, s49, 0xffff
    s_mov_b32 s22, 1966080
    s_mov_b32 s23, 0x00020000
    v_mul_u32_u24 v2, 86, v0
    v_lshrrev_b32 v2, 8, v2
    v_mul_u32_u24 v3, 3, v2
    v_sub_u32 v3, v0, v3
    v_mul_u32_u24 v2, 3072, v2
    v_lshl_add_u32 v2, v3, 7, v2
    s_mul_i32 s74, s73, 46080
    s_mul_i32 s75, s61, 384
    s_add_u32 s74, s74, s75
    s_mov_b32 exec_hi, 0x1fff
    buffer_load_dword v34, v2, s[20:23], s74 offen nt
    s_mov_b64 exec, -1
    s_waitcnt vmcnt(0)
    s_barrier
L_pf2_done:
    s_mul_i32 s91, s66, 6080
    s_add_u32 s91, s91, 139264
    s_cmp_ge_u32 s62, 20
    s_cbranch_scc1 L_SA
    s_branch L_ZA
L_SM:
    s_sub_u32 s69, s62, 20
    s_mul_i32 s67, s69, 43
    s_lshr_b32 s67, s67, 7
    s_mul_i32 s68, s67, 3
    s_sub_u32 s68, s69, s68
    s_lshl_b32 s72, s61, 2
    s_add_u32 s67, s67, s72
    s_mov_b32 s20, s36
    s_and_b32 s21, s37, 0xffff
    s_mov_b32 s22, 7864320
    s_mov_b32 s23, 0x00020000
    s_mov_b32 s24, s38
    s_and_b32 s25, s39, 0xffff
    s_mov_b32 s26, 7864320
    s_mov_b32 s27, 0x00020000
    s_mul_i32 s80, s67, 384
    s_lshl_b32 s73, s68, 7
    s_add_u32 s80, s80, s73
    s_mul_i32 s73, s66, 983040
    s_add_u32 s80, s80, s73
    s_mul_i32 s91, s66, 10240
    v_lshrrev_b32 v9, 3, v0
    v_and_b32 v10, 2, v9
    v_and_b32 v11, 7, v0
    v_xor_b32 v11, v11, v10
    v_mul_u32_u24 v9, 12288, v9
    v_lshl_add_u32 v6, v11, 4, v9
    v_xor_b32 v7, 64, v6
    v_bfe_u32 v9, v0, 3, 1
    v_bfe_u32 v10, v0, 4, 1
    v_lshl_add_u32 v9, v10, 1, v9
    v_xor_b32 v9, s66, v9
    v_lshlrev_b32 v9, 5, v9
    v_and_b32 v10, 3, v0
    v_lshl_add_u32 v9, v10, 3, v9
    v_bfe_u32 v10, v0, 2, 2
    v_lshl_add_u32 v9, v10, 7, v9
    v_lshrrev_b32 v10, 4, v0
    v_lshl_add_u32 v1, v10, 10, v9
    s_barrier
    s_sleep 2
    s_add_u32 m0, s91, 40960
    s_add_u32 s72, s80, 0
    buffer_load_dwordx4 v6, s[20:23], s72 offen nt lds
    s_add_u32 m0, s91, 41984
    s_add_u32 s72, s80, 98304
    buffer_load_dwordx4 v7, s[20:23], s72 offen nt lds
    s_add_u32 m0, s91, 43008
    s_add_u32 s72, s80, 196608
    buffer_load_dwordx4 v6, s[20:23], s72 offen nt lds
    s_add_u32 m0, s91, 44032
    s_add_u32 s72, s80, 294912
    buffer_load_dwordx4 v7, s[20:23], s72 offen nt lds
    s_add_u32 m0, s91, 45056
    s_add_u32 s72, s80, 393216
    buffer_load_dwordx4 v6, s[20:23], s72 offen nt lds
    s_add_u32 m0, s91, 46080
    s_add_u32 s72, s80, 491520
    buffer_load_dwordx4 v7, s[20:23], s72 offen nt lds
    s_add_u32 m0, s91, 47104
    s_add_u32 s72, s80, 589824
    buffer_load_dwordx4 v6, s[20:23], s72 offen nt lds
    s_add_u32 m0, s91, 48128
    s_add_u32 s72, s80, 688128
    buffer_load_dwordx4 v7, s[20:23], s72 offen nt lds
    s_add_u32 m0, s91, 49152
    s_add_u32 s72, s80, 786432
    buffer_load_dwordx4 v6, s[20:23], s72 offen nt lds
    s_add_u32 m0, s91, 50176
    s_add_u32 s72, s80, 884736
    buffer_load_dwordx4 v7, s[20:23], s72 offen nt lds
    s_add_u32 m0, s91, 81920
    s_add_u32 s72, s80, 3932160
    buffer_load_dwordx4 v6, s[20:23], s72 offen nt lds
    s_add_u32 m0, s91, 82944
    s_add_u32 s72, s80, 4030464
    buffer_load_dwordx4 v7, s[20:23], s72 offen nt lds
    s_add_u32 m0, s91, 83968
    s_add_u32 s72, s80, 4128768
    buffer_load_dwordx4 v6, s[20:23], s72 offen nt lds
    s_add_u32 m0, s91, 84992
    s_add_u32 s72, s80, 4227072
    buffer_load_dwordx4 v7, s[20:23], s72 offen nt lds
    s_add_u32 m0, s91, 86016
    s_add_u32 s72, s80, 4325376
    buffer_load_dwordx4 v6, s[20:23], s72 offen nt lds
    s_add_u32 m0, s91, 87040
    s_add_u32 s72, s80, 4423680
    buffer_load_dwordx4 v7, s[20:23], s72 offen nt lds
    s_add_u32 m0, s91, 88064
    s_add_u32 s72, s80, 4521984
    buffer_load_dwordx4 v6, s[20:23], s72 offen nt lds
    s_add_u32 m0, s91, 89088
    s_add_u32 s72, s80, 4620288
    buffer_load_dwordx4 v7, s[20:23], s72 offen nt lds
    s_add_u32 m0, s91, 90112
    s_add_u32 s72, s80, 4718592
    buffer_load_dwordx4 v6, s[20:23], s72 offen nt lds
    s_add_u32 m0, s91, 91136
    s_add_u32 s72, s80, 4816896
    buffer_load_dwordx4 v7, s[20:23], s72 offen nt lds
    s_add_u32 m0, s91, 0
    s_add_u32 s72, s80, 0
    buffer_load_dwordx4 v6, s[24:27], s72 offen nt lds
    s_add_u32 m0, s91, 1024
    s_add_u32 s72, s80, 98304
    buffer_load_dwordx4 v7, s[24:27], s72 offen nt lds
    s_add_u32 m0, s91, 2048
    s_add_u32 s72, s80, 196608
    buffer_load_dwordx4 v6, s[24:27], s72 offen nt lds
    s_add_u32 m0, s91, 3072
    s_add_u32 s72, s80, 294912
    buffer_load_dwordx4 v7, s[24:27], s72 offen nt lds
    s_add_u32 m0, s91, 4096
    s_add_u32 s72, s80, 393216
    buffer_load_dwordx4 v6, s[24:27], s72 offen nt lds
    s_add_u32 m0, s91, 5120
    s_add_u32 s72, s80, 491520
    buffer_load_dwordx4 v7, s[24:27], s72 offen nt lds
    s_add_u32 m0, s91, 6144
    s_add_u32 s72, s80, 589824
    buffer_load_dwordx4 v6, s[24:27], s72 offen nt lds
    s_add_u32 m0, s91, 7168
    s_add_u32 s72, s80, 688128
    buffer_load_dwordx4 v7, s[24:27], s72 offen nt lds
    s_add_u32 m0, s91, 8192
    s_add_u32 s72, s80, 786432
    buffer_load_dwordx4 v6, s[24:27], s72 offen nt lds
    s_add_u32 m0, s91, 9216
    s_add_u32 s72, s80, 884736
    buffer_load_dwordx4 v7, s[24:27], s72 offen nt lds
    s_waitcnt vmcnt(20)
    s_barrier
    v_add_u32 v9, 40960, v1
    ds_read_b64_tr_b16 v[12:13], v9 offset:0
    ds_read_b64_tr_b16 v[14:15], v9 offset:512
    ds_read_b64_tr_b16 v[16:17], v9 offset:4096
    ds_read_b64_tr_b16 v[18:19], v9 offset:4608
    ds_read_b64_tr_b16 v[20:21], v9 offset:8192
    ds_read_b64_tr_b16 v[22:23], v9 offset:8704
    ds_read_b64_tr_b16 v[24:25], v9 offset:12288
    ds_read_b64_tr_b16 v[26:27], v9 offset:12800
    ds_read_b64_tr_b16 v[28:29], v9 offset:16384
    ds_read_b64_tr_b16 v[30:31], v9 offset:16896
    ds_read_b64_tr_b16 v[32:33], v9 offset:20480
    ds_read_b64_tr_b16 v[34:35], v9 offset:20992
    ds_read_b64_tr_b16 v[36:37], v9 offset:24576
    ds_read_b64_tr_b16 v[38:39], v9 offset:25088
    ds_read_b64_tr_b16 v[40:41], v9 offset:28672
    ds_read_b64_tr_b16 v[42:43], v9 offset:29184
    ds_read_b64_tr_b16 v[44:45], v9 offset:32768
    ds_read_b64_tr_b16 v[46:47], v9 offset:33280
    ds_read_b64_tr_b16 v[48:49], v9 offset:36864
    ds_read_b64_tr_b16 v[50:51], v9 offset:37376
    s_waitcnt lgkmcnt(0)
    s_waitcnt vmcnt(10)
    s_barrier
    s_add_u32 m0, s91, 40960
    s_add_u32 s72, s80, 3932160
    buffer_load_dwordx4 v6, s[24:27], s72 offen nt lds
    s_add_u32 m0, s91, 41984
    s_add_u32 s72, s80, 4030464
    buffer_load_dwordx4 v7, s[24:27], s72 offen nt lds
    s_add_u32 m0, s91, 43008
    s_add_u32 s72, s80, 4128768
    buffer_load_dwordx4 v6, s[24:27], s72 offen nt lds
    s_add_u32 m0, s91, 44032
    s_add_u32 s72, s80, 4227072
    buffer_load_dwordx4 v7, s[24:27], s72 offen nt lds
    s_add_u32 m0, s91, 45056
    s_add_u32 s72, s80, 4325376
    buffer_load_dwordx4 v6, s[24:27], s72 offen nt lds
    s_add_u32 m0, s91, 46080
    s_add_u32 s72, s80, 4423680
    buffer_load_dwordx4 v7, s[24:27], s72 offen nt lds
    s_add_u32 m0, s91, 47104
    s_add_u32 s72, s80, 4521984
    buffer_load_dwordx4 v6, s[24:27], s72 offen nt lds
    s_add_u32 m0, s91, 48128
    s_add_u32 s72, s80, 4620288
    buffer_load_dwordx4 v7, s[24:27], s72 offen nt lds
    s_add_u32 m0, s91, 49152
    s_add_u32 s72, s80, 4718592
    buffer_load_dwordx4 v6, s[24:27], s72 offen nt lds
    s_add_u32 m0, s91, 50176
    s_add_u32 s72, s80, 4816896
    buffer_load_dwordx4 v7, s[24:27], s72 offen nt lds
    v_add_u32 v9, 81920, v1
    ds_read_b64_tr_b16 v[52:53], v9 offset:0
    ds_read_b64_tr_b16 v[54:55], v9 offset:512
    ds_read_b64_tr_b16 v[56:57], v9 offset:4096
    ds_read_b64_tr_b16 v[58:59], v9 offset:4608
    ds_read_b64_tr_b16 v[60:61], v9 offset:8192
    ds_read_b64_tr_b16 v[62:63], v9 offset:8704
    ds_read_b64_tr_b16 v[64:65], v9 offset:12288
    ds_read_b64_tr_b16 v[66:67], v9 offset:12800
    ds_read_b64_tr_b16 v[68:69], v9 offset:16384
    ds_read_b64_tr_b16 v[70:71], v9 offset:16896
    ds_read_b64_tr_b16 v[72:73], v9 offset:20480
    ds_read_b64_tr_b16 v[74:75], v9 offset:20992
    ds_read_b64_tr_b16 v[76:77], v9 offset:24576
    ds_read_b64_tr_b16 v[78:79], v9 offset:25088
    ds_read_b64_tr_b16 v[80:81], v9 offset:28672
    ds_read_b64_tr_b16 v[82:83], v9 offset:29184
    ds_read_b64_tr_b16 v[84:85], v9 offset:32768
    ds_read_b64_tr_b16 v[86:87], v9 offset:33280
    ds_read_b64_tr_b16 v[88:89], v9 offset:36864
    ds_read_b64_tr_b16 v[90:91], v9 offset:37376
    s_waitcnt lgkmcnt(0)
    s_waitcnt vmcnt(10)
    s_barrier
    v_add_u32 v9, 0, v1
    ds_read_b64_tr_b16 v[92:93], v9 offset:0
    ds_read_b64_tr_b16 v[94:95], v9 offset:512
    ds_read_b64_tr_b16 v[96:97], v9 offset:4096
    ds_read_b64_tr_b16 v[98:99], v9 offset:4608
    ds_read_b64_tr_b16 v[100:101], v9 offset:8192
    ds_read_b64_tr_b16 v[102:103], v9 offset:8704
    ds_read_b64_tr_b16 v[104:105], v9 offset:12288
    ds_read_b64_tr_b16 v[106:107], v9 offset:12800
    ds_read_b64_tr_b16 v[108:109], v9 offset:16384
    ds_read_b64_tr_b16 v[110:111], v9 offset:16896
    ds_read_b64_tr_b16 v[112:113], v9 offset:20480
    ds_read_b64_tr_b16 v[114:115], v9 offset:20992
    ds_read_b64_tr_b16 v[116:117], v9 offset:24576
    ds_read_b64_tr_b16 v[118:119], v9 offset:25088
    ds_read_b64_tr_b16 v[120:121], v9 offset:28672
    ds_read_b64_tr_b16 v[122:123], v9 offset:29184
    ds_read_b64_tr_b16 v[124:125], v9 offset:32768
    ds_read_b64_tr_b16 v[126:127], v9 offset:33280
    ds_read_b64_tr_b16 v[128:129], v9 offset:36864
    ds_read_b64_tr_b16 v[130:131], v9 offset:37376
    s_waitcnt lgkmcnt(0)
    s_waitcnt vmcnt(0)
    s_barrier
    v_add_u32 v9, 40960, v1
    ds_read_b64_tr_b16 v[132:133], v9 offset:0
    ds_read_b64_tr_b16 v[134:135], v9 offset:512
    ds_read_b64_tr_b16 v[136:137], v9 offset:4096
    ds_read_b64_tr_b16 v[138:139], v9 offset:4608
    ds_read_b64_tr_b16 v[140:141], v9 offset:8192
    ds_read_b64_tr_b16 v[142:143], v9 offset:8704
    ds_read_b64_tr_b16 v[144:145], v9 offset:12288
    ds_read_b64_tr_b16 v[146:147], v9 offset:12800
    ds_read_b64_tr_b16 v[148:149], v9 offset:16384
    ds_read_b64_tr_b16 v[150:151], v9 offset:16896
    ds_read_b64_tr_b16 v[152:153], v9 offset:20480
    ds_read_b64_tr_b16 v[154:155], v9 offset:20992
    ds_read_b64_tr_b16 v[156:157], v9 offset:24576
    ds_read_b64_tr_b16 v[158:159], v9 offset:25088
    ds_read_b64_tr_b16 v[160:161], v9 offset:28672
    ds_read_b64_tr_b16 v[162:163], v9 offset:29184
    ds_read_b64_tr_b16 v[164:165], v9 offset:32768
    ds_read_b64_tr_b16 v[166:167], v9 offset:33280
    ds_read_b64_tr_b16 v[168:169], v9 offset:36864
    ds_read_b64_tr_b16 v[170:171], v9 offset:37376
    s_waitcnt lgkmcnt(0)
    v_bfe_u32 v2, v0, 2, 2
    v_lshlrev_b32 v2, 1, v2
    v_and_b32 v9, 1, v0
    v_add_u32 v2, v2, v9
    v_lshlrev_b32 v2, 4, v2
    v_bfe_u32 v9, v0, 1, 1
    v_lshl_add_u32 v2, v9, 7, v2
    v_lshrrev_b32 v10, 4, v0
    v_lshl_add_u32 v2, v10, 8, v2
    v_add_u32 v2, 81920, v2
    v_mul_u32_u24 v3, 0xaaaa, v9
    v_add_u32 v3, 0x4444, v3
    v_lshrrev_b32 v9, 4, v0
    v_lshlrev_b32 v4, 9, v9
    v_and_b32 v10, 1, v9
    v_lshl_add_u32 v4, v10, 5, v4
    v_lshrrev_b32 v10, 1, v9
    v_lshl_add_u32 v4, v10, 7, v4
    v_add_u32 v4, 92160, v4
    v_and_b32 v10, 15, v0
    v_lshl_add_u32 v4, v10, 3, v4
    s_lshl_b32 s73, s66, 7
    v_add_u32 v4, s73, v4
    v_lshrrev_b32 v10, 5, v0
    v_bfe_u32 v11, v0, 4, 1
    v_and_b32 v5, 15, v0
    v_lshlrev_b32 v5, 4, v5
    v_lshl_add_u32 v5, v10, 8, v5
    v_lshl_add_u32 v5, v11, 3, v5
    s_lshl_b32 s73, s66, 9
    s_add_u32 s73, s73, 98304
    v_add_u32 v5, s73, v5
    v_lshlrev_b32 v1, 4, v0
    s_mul_i32 s73, s66, 1024
    s_add_u32 s73, s73, 0
    v_add_u32 v6, s73, v1
    v_add_u32 v7, 81920, v6
    s_mul_i32 s80, s61, 10240
    s_add_u32 s80, s80, 5563392
    v_mov_b32 v8, 151552
    s_mov_b32 s64, -1
    s_barrier
    v_mov_b32 v9, 163584
    ds_read_b32 v9, v9 offset:32
    s_waitcnt lgkmcnt(0)
    v_readfirstlane_b32 s63, v9
    s_nop 0
    s_cmp_lt_i32 s63, 0
    s_cbranch_scc1 L_redo
    s_branch L_SM_bulk
L_SM_loop:
    s_and_b32 s83, s64, 3
    s_mul_i32 s83, s83, 475136
    s_add_u32 s83, s83, s80
    v_mov_b32 v228, 0
    v_mov_b32 v229, 0
    v_mov_b32 v230, 0
    v_mov_b32 v231, 0
    v_mov_b32 v232, 0
    v_mov_b32 v233, 0
    v_mov_b32 v234, 0
    v_mov_b32 v235, 0
    s_setprio 2
Lflag_1:
    ds_read_b32 v9, v8
    s_waitcnt lgkmcnt(0)
    v_cmp_gt_i32 vcc, s64, v9
    s_cbranch_vccz Lflagd_2
    s_sleep 1
    s_branch Lflag_1
Lflagd_2:
    buffer_load_dwordx4 v[172:175], v6, s[4:7], s83 offen offset:0 sc1
    s_sleep 2
Lpoll_3:
    buffer_load_dwordx4 v[176:179], v6, s[4:7], s83 offen offset:0 sc1
    s_waitcnt vmcnt(1)
    ds_write_b128 v7, v[172:175] offset:0
    v_max3_u32 v9, v172, v173, v174
    v_max_u32 v9, v9, v175
    v_cmp_eq_u32 vcc, -1, v9
    s_cbranch_vccz Ldone_4
    buffer_load_dwordx4 v[172:175], v6, s[4:7], s83 offen offset:0 sc1
    s_waitcnt vmcnt(1)
    ds_write_b128 v7, v[176:179] offset:0
    v_max3_u32 v9, v176, v177, v178
    v_max_u32 v9, v9, v179
    v_cmp_eq_u32 vcc, -1, v9
    s_cbranch_vccz Ldone_4
    s_sub_u32 s65, s65, 1
    s_cbranch_scc0 Lpoll_3
    s_mov_b32 s65, 0
Ldone_4:
    s_waitcnt lgkmcnt(0)
    s_barrier
    ds_read_b128 v[188:191], v2 offset:0
    ds_read_b128 v[192:195], v2 offset:1024
    ds_read_b128 v[196:199], v2 offset:2048
    ds_read_b128 v[200:203], v2 offset:3072
    ds_read_b128 v[204:207], v2 offset:4096
    ds_read_b128 v[208:211], v2 offset:5120
    ds_read_b128 v[212:215], v2 offset:6144
    ds_read_b128 v[216:219], v2 offset:7168
    ds_read_b128 v[220:223], v2 offset:8192
    ds_read_b128 v[224:227], v2 offset:9216
    s_waitcnt lgkmcnt(9)
    v_smfmac_f32_16x16x64_bf16 v[228:231], v[188:191], v[12:19], v3
    v_smfmac_f32_16x16x64_bf16 v[232:235], v[188:191], v[92:99], v3
    s_waitcnt lgkmcnt(8)
    v_smfmac_f32_16x16x64_bf16 v[228:231], v[192:195], v[20:27], v3
    v_smfmac_f32_16x16x64_bf16 v[232:235], v[192:195], v[100:107], v3
    s_waitcnt lgkmcnt(7)
    v_smfmac_f32_16x16x64_bf16 v[228:231], v[196:199], v[28:35], v3
    v_smfmac_f32_16x16x64_bf16 v[232:235], v[196:199], v[108:115], v3
    s_waitcnt lgkmcnt(6)
    v_smfmac_f32_16x16x64_bf16 v[228:231], v[200:203], v[36:43], v3
    v_smfmac_f32_16x16x64_bf16 v[232:235], v[200:203], v[116:123], v3
    s_waitcnt lgkmcnt(5)
    v_smfmac_f32_16x16x64_bf16 v[228:231], v[204:207], v[44:51], v3
    v_smfmac_f32_16x16x64_bf16 v[232:235], v[204:207], v[124:131], v3
    s_waitcnt lgkmcnt(4)
    v_smfmac_f32_16x16x64_bf16 v[228:231], v[208:211], v[52:59], v3
    v_smfmac_f32_16x16x64_bf16 v[232:235], v[208:211], v[132:139], v3
    s_waitcnt lgkmcnt(3)
    v_smfmac_f32_16x16x64_bf16 v[228:231], v[212:215], v[60:67], v3
    v_smfmac_f32_16x16x64_bf16 v[232:235], v[212:215], v[140:147], v3
    s_waitcnt lgkmcnt(2)
    v_smfmac_f32_16x16x64_bf16 v[228:231], v[216:219], v[68:75], v3
    v_smfmac_f32_16x16x64_bf16 v[232:235], v[216:219], v[148:155], v3
    s_waitcnt lgkmcnt(1)
    v_smfmac_f32_16x16x64_bf16 v[228:231], v[220:223], v[76:83], v3
    v_smfmac_f32_16x16x64_bf16 v[232:235], v[220:223], v[156:163], v3
    s_waitcnt lgkmcnt(0)
    v_smfmac_f32_16x16x64_bf16 v[228:231], v[224:227], v[84:91], v3
    v_smfmac_f32_16x16x64_bf16 v[232:235], v[224:227], v[164:171], v3
    s_nop 6
    v_add_f32 v228, v228, v230
    v_add_f32 v229, v229, v231
    v_add_f32 v232, v232, v234
    v_add_f32 v233, v233, v235
    v_cvt_pk_bf16_f32 v237, v228, v229
    v_cvt_pk_bf16_f32 v236, v232, v233
    ds_write_b64 v4, v[236:237]
    s_waitcnt vmcnt(0) lgkmcnt(0)
    s_barrier
    s_setprio 0
    s_sleep 2
L_SM_bulk:
    s_cmp_ge_i32 s64, 63
    s_cbranch_scc1 L_SM_next
    ds_read_b128 v[188:191], v1 offset:0
    ds_read_b128 v[192:195], v1 offset:1024
    ds_read_b128 v[196:199], v1 offset:2048
    ds_read_b128 v[200:203], v1 offset:3072
    ds_read_b128 v[204:207], v1 offset:4096
    ds_read_b128 v[208:211], v1 offset:5120
    ds_read_b128 v[212:215], v1 offset:6144
    ds_read_b128 v[216:219], v1 offset:7168
    s_waitcnt lgkmcnt(6)
    v_mfma_f32_16x16x32_bf16 v[172:175], v[12:15], v[188:191], 0
    ds_read_b128 v[220:223], v1 offset:8192
    v_mfma_f32_16x16x32_bf16 v[180:183], v[92:95], v[188:191], 0
    ds_read_b128 v[224:227], v1 offset:9216
    v_mfma_f32_16x16x32_bf16 v[176:179], v[12:15], v[192:195], 0
    s_waitcnt lgkmcnt(6)
    v_mfma_f32_16x16x32_bf16 v[184:187], v[92:95], v[192:195], 0
    v_mfma_f32_16x16x32_bf16 v[172:175], v[16:19], v[196:199], v[172:175]
    ds_read_b128 v[188:191], v1 offset:10240
    v_mfma_f32_16x16x32_bf16 v[180:183], v[96:99], v[196:199], v[180:183]
    ds_read_b128 v[192:195], v1 offset:11264
    v_mfma_f32_16x16x32_bf16 v[176:179], v[16:19], v[200:203], v[176:179]
    s_waitcnt lgkmcnt(6)
    v_mfma_f32_16x16x32_bf16 v[184:187], v[96:99], v[200:203], v[184:187]
    v_mfma_f32_16x16x32_bf16 v[172:175], v[20:23], v[204:207], v[172:175]
    ds_read_b128 v[196:199], v1 offset:12288
    v_mfma_f32_16x16x32_bf16 v[180:183], v[100:103], v[204:207], v[180:183]
    ds_read_b128 v[200:203], v1 offset:13312
    v_mfma_f32_16x16x32_bf16 v[176:179], v[20:23], v[208:211], v[176:179]
    s_waitcnt lgkmcnt(6)
    v_mfma_f32_16x16x32_bf16 v[184:187], v[100:103], v[208:211], v[184:187]
    v_mfma_f32_16x16x32_bf16 v[172:175], v[24:27], v[212:215], v[172:175]
    ds_read_b128 v[204:207], v1 offset:14336
    v_mfma_f32_16x16x32_bf16 v[180:183], v[104:107], v[212:215], v[180:183]
    ds_read_b128 v[208:211], v1 offset:15360
    v_mfma_f32_16x16x32_bf16 v[176:179], v[24:27], v[216:219], v[176:179]
    s_waitcnt lgkmcnt(6)
    v_mfma_f32_16x16x32_bf16 v[184:187], v[104:107], v[216:219], v[184:187]
    v_mfma_f32_16x16x32_bf16 v[172:175], v[28:31], v[220:223], v[172:175]
    ds_read_b128 v[212:215], v1 offset:16384
    v_mfma_f32_16x16x32_bf16 v[180:183], v[108:111], v[220:223], v[180:183]
    ds_read_b128 v[216:219], v1 offset:17408
    v_mfma_f32_16x16x32_bf16 v[176:179], v[28:31], v[224:227], v[176:179]
    s_waitcnt lgkmcnt(6)
    v_mfma_f32_16x16x32_bf16 v[184:187], v[108:111], v[224:227], v[184:187]
    v_mfma_f32_16x16x32_bf16 v[172:175], v[32:35], v[188:191], v[172:175]
    ds_read_b128 v[220:223], v1 offset:18432
    v_mfma_f32_16x16x32_bf16 v[180:183], v[112:115], v[188:191], v[180:183]
    ds_read_b128 v[224:227], v1 offset:19456
    v_mfma_f32_16x16x32_bf16 v[176:179], v[32:35], v[192:195], v[176:179]
    s_waitcnt lgkmcnt(6)
    v_mfma_f32_16x16x32_bf16 v[184:187], v[112:115], v[192:195], v[184:187]
    v_mfma_f32_16x16x32_bf16 v[172:175], v[36:39], v[196:199], v[172:175]
    ds_read_b128 v[188:191], v1 offset:20480
    v_mfma_f32_16x16x32_bf16 v[180:183], v[116:119], v[196:199], v[180:183]
    ds_read_b128 v[192:195], v1 offset:21504
    v_mfma_f32_16x16x32_bf16 v[176:179], v[36:39], v[200:203], v[176:179]
    s_waitcnt lgkmcnt(6)
    v_mfma_f32_16x16x32_bf16 v[184:187], v[116:119], v[200:203], v[184:187]
    v_mfma_f32_16x16x32_bf16 v[172:175], v[40:43], v[204:207], v[172:175]
    ds_read_b128 v[196:199], v1 offset:22528
    v_mfma_f32_16x16x32_bf16 v[180:183], v[120:123], v[204:207], v[180:183]
    ds_read_b128 v[200:203], v1 offset:23552
    v_mfma_f32_16x16x32_bf16 v[176:179], v[40:43], v[208:211], v[176:179]
    s_waitcnt lgkmcnt(6)
    v_mfma_f32_16x16x32_bf16 v[184:187], v[120:123], v[208:211], v[184:187]
    v_mfma_f32_16x16x32_bf16 v[172:175], v[44:47], v[212:215], v[172:175]
    ds_read_b128 v[204:207], v1 offset:24576
    v_mfma_f32_16x16x32_bf16 v[180:183], v[124:127], v[212:215], v[180:183]
    ds_read_b128 v[208:211], v1 offset:25600
    v_mfma_f32_16x16x32_bf16 v[176:179], v[44:47], v[216:219], v[176:179]
    s_waitcnt lgkmcnt(6)
    v_mfma_f32_16x16x32_bf16 v[184:187], v[124:127], v[216:219], v[184:187]
    v_mfma_f32_16x16x32_bf16 v[172:175], v[48:51], v[220:223], v[172:175]
    ds_read_b128 v[212:215], v1 offset:26624
    v_mfma_f32_16x16x32_bf16 v[180:183], v[128:131], v[220:223], v[180:183]
    ds_read_b128 v[216:219], v1 offset:27648
    v_mfma_f32_16x16x32_bf16 v[176:179], v[48:51], v[224:227], v[176:179]
    s_waitcnt lgkmcnt(6)
    v_mfma_f32_16x16x32_bf16 v[184:187], v[128:131], v[224:227], v[184:187]
    v_mfma_f32_16x16x32_bf16 v[172:175], v[52:55], v[188:191], v[172:175]
    ds_read_b128 v[220:223], v1 offset:28672
    v_mfma_f32_16x16x32_bf16 v[180:183], v[132:135], v[188:191], v[180:183]
    ds_read_b128 v[224:227], v1 offset:29696
    v_mfma_f32_16x16x32_bf16 v[176:179], v[52:55], v[192:195], v[176:179]
    s_waitcnt lgkmcnt(6)
    v_mfma_f32_16x16x32_bf16 v[184:187], v[132:135], v[192:195], v[184:187]
    v_mfma_f32_16x16x32_bf16 v[172:175], v[56:59], v[196:199], v[172:175]
    ds_read_b128 v[188:191], v1 offset:30720
    v_mfma_f32_16x16x32_bf16 v[180:183], v[136:139], v[196:199], v[180:183]
    ds_read_b128 v[192:195], v1 offset:31744
    v_mfma_f32_16x16x32_bf16 v[176:179], v[56:59], v[200:203], v[176:179]
    s_waitcnt lgkmcnt(6)
    v_mfma_f32_16x16x32_bf16 v[184:187], v[136:139], v[200:203], v[184:187]
    v_mfma_f32_16x16x32_bf16 v[172:175], v[60:63], v[204:207], v[172:175]
    ds_read_b128 v[196:199], v1 offset:32768
    v_mfma_f32_16x16x32_bf16 v[180:183], v[140:143], v[204:207], v[180:183]
    ds_read_b128 v[200:203], v1 offset:33792
    v_mfma_f32_16x16x32_bf16 v[176:179], v[60:63], v[208:211], v[176:179]
    s_waitcnt lgkmcnt(6)
    v_mfma_f32_16x16x32_bf16 v[184:187], v[140:143], v[208:211], v[184:187]
    v_mfma_f32_16x16x32_bf16 v[172:175], v[64:67], v[212:215], v[172:175]
    ds_read_b128 v[204:207], v1 offset:34816
    v_mfma_f32_16x16x32_bf16 v[180:183], v[144:147], v[212:215], v[180:183]
    ds_read_b128 v[208:211], v1 offset:35840
    v_mfma_f32_16x16x32_bf16 v[176:179], v[64:67], v[216:219], v[176:179]
    s_waitcnt lgkmcnt(6)
    v_mfma_f32_16x16x32_bf16 v[184:187], v[144:147], v[216:219], v[184:187]
    v_mfma_f32_16x16x32_bf16 v[172:175], v[68:71], v[220:223], v[172:175]
    ds_read_b128 v[212:215], v1 offset:36864
    v_mfma_f32_16x16x32_bf16 v[180:183], v[148:151], v[220:223], v[180:183]
    ds_read_b128 v[216:219], v1 offset:37888
    v_mfma_f32_16x16x32_bf16 v[176:179], v[68:71], v[224:227], v[176:179]
    s_waitcnt lgkmcnt(6)
    v_mfma_f32_16x16x32_bf16 v[184:187], v[148:151], v[224:227], v[184:187]
    v_mfma_f32_16x16x32_bf16 v[172:175], v[72:75], v[188:191], v[172:175]
    ds_read_b128 v[220:223], v1 offset:38912
    v_mfma_f32_16x16x32_bf16 v[180:183], v[152:155], v[188:191], v[180:183]
    ds_read_b128 v[224:227], v1 offset:39936
    v_mfma_f32_16x16x32_bf16 v[176:179], v[72:75], v[192:195], v[176:179]
    s_waitcnt lgkmcnt(6)
    v_mfma_f32_16x16x32_bf16 v[184:187], v[152:155], v[192:195], v[184:187]
    v_mfma_f32_16x16x32_bf16 v[172:175], v[76:79], v[196:199], v[172:175]
    v_mfma_f32_16x16x32_bf16 v[180:183], v[156:159], v[196:199], v[180:183]
    v_mfma_f32_16x16x32_bf16 v[176:179], v[76:79], v[200:203], v[176:179]
    s_waitcnt lgkmcnt(4)
    v_mfma_f32_16x16x32_bf16 v[184:187], v[156:159], v[200:203], v[184:187]
    v_mfma_f32_16x16x32_bf16 v[172:175], v[80:83], v[204:207], v[172:175]
    v_mfma_f32_16x16x32_bf16 v[180:183], v[160:163], v[204:207], v[180:183]
    v_mfma_f32_16x16x32_bf16 v[176:179], v[80:83], v[208:211], v[176:179]
    s_waitcnt lgkmcnt(2)
    v_mfma_f32_16x16x32_bf16 v[184:187], v[160:163], v[208:211], v[184:187]
    v_mfma_f32_16x16x32_bf16 v[172:175], v[84:87], v[212:215], v[172:175]
    v_mfma_f32_16x16x32_bf16 v[180:183], v[164:167], v[212:215], v[180:183]
    v_mfma_f32_16x16x32_bf16 v[176:179], v[84:87], v[216:219], v[176:179]
    s_waitcnt lgkmcnt(0)
    v_mfma_f32_16x16x32_bf16 v[184:187], v[164:167], v[216:219], v[184:187]
    v_mfma_f32_16x16x32_bf16 v[172:175], v[88:91], v[220:223], v[172:175]
    v_mfma_f32_16x16x32_bf16 v[180:183], v[168:171], v[220:223], v[180:183]
    v_mfma_f32_16x16x32_bf16 v[176:179], v[88:91], v[224:227], v[176:179]
    v_mfma_f32_16x16x32_bf16 v[184:187], v[168:171], v[224:227], v[184:187]
    s_nop 4
    v_cvt_pk_bf16_f32 v236, v172, v173
    v_cvt_pk_bf16_f32 v237, v174, v175
    v_cvt_pk_bf16_f32 v238, v176, v177
    v_cvt_pk_bf16_f32 v239, v178, v179
    v_cvt_pk_bf16_f32 v240, v180, v181
    v_cvt_pk_bf16_f32 v241, v182, v183
    v_cvt_pk_bf16_f32 v242, v184, v185
    v_cvt_pk_bf16_f32 v243, v186, v187
    ds_write_b64 v5, v[236:237]
    ds_write_b64 v5, v[238:239] offset:2048
    ds_write_b64 v5, v[240:241] offset:8192
    ds_write_b64 v5, v[242:243] offset:10240
    v_xor_b32 v1, 40960, v1
    v_xor_b32 v5, 4096, v5
L_SM_next:
    s_add_u32 s64, s64, 1
    s_cmp_lt_i32 s64, 64
    s_cbranch_scc1 L_SM_loop
    s_endpgm
L_SA:
    s_sub_u32 s69, s62, 20
    s_mul_i32 s67, s69, 43
    s_lshr_b32 s67, s67, 7
    s_mul_i32 s68, s67, 3
    s_sub_u32 s68, s69, s68
    s_lshl_b32 s72, s61, 2
    s_add_u32 s67, s67, s72
    v_mov_b32 v52, -1
    v_mov_b32 v53, -1
    v_mov_b32 v54, -1
    v_mov_b32 v55, -1
    v_lshlrev_b32 v11, 3, v0
    v_lshlrev_b32 v12, 2, v0
    v_add_u32 v13, 151552, v12
    v_and_b32 v2, 3, v0
    v_lshlrev_b32 v7, 9, v2
    v_and_b32 v3, 1, v2
    v_lshl_add_u32 v7, v3, 5, v7
    v_lshrrev_b32 v3, 1, v2
    v_lshl_add_u32 v7, v3, 7, v7
    v_add_u32 v7, 92160, v7
    v_bfe_u32 v2, v0, 2, 2
    v_lshl_add_u32 v7, v2, 3, v7
    v_lshrrev_b32 v2, 4, v0
    v_lshl_add_u32 v7, v2, 6, v7
    v_add_u32 v8, 98304, v1
    v_bfe_u32 v3, v0, 2, 2
    v_lshlrev_b32 v3, 1, v3
    v_and_b32 v4, 1, v0
    v_add_u32 v3, v3, v4
    s_mov_b32 s92, 0x33333333
    s_mov_b32 s93, 0x33333333
    s_mul_i32 s80, s61, 10240
    s_add_u32 s80, s80, 5563392
    s_lshl_b32 s81, s67, 11
    s_add_u32 s81, s81, 5645312
    s_cmp_ge_u32 s66, 2
    s_cbranch_scc1 L_SA23
    s_mul_i32 s73, s66, 2048
    s_add_u32 s73, s73, 4096
    v_add_u32 v5, s73, v1
    v_add_u32 v6, 81920, v5
    v_and_b32 v9, 15, v0
    v_lshlrev_b32 v9, 4, v9
    v_lshl_add_u32 v9, v2, 2, v9
    s_lshl_b32 s73, s66, 9
    s_and_b32 s74, s68, 1
    s_lshl_b32 s74, s74, 8
    s_add_u32 s73, s73, s74
    s_lshr_b32 s74, s68, 1
    s_lshl_b32 s74, s74, 10
    s_add_u32 s73, s73, s74
    v_add_u32 v9, s73, v9
    s_mul_i32 s29, s66, 20480
    s_add_u32 s28, s29, 40960
    s_lshl_b32 s30, s29, 1
    s_add_u32 s30, s30, 40960
    s_add_u32 s29, s29, 40960
    s_lshl_b32 s73, s66, 11
    v_add_u32 v8, s73, v8
    s_mul_i32 s86, s66, 12
    s_add_u32 s86, s86, s69
    v_bfe_u32 v2, v0, 4, 1
    v_bfe_u32 v3, v0, 3, 1
    v_lshl_add_u32 v2, v3, 1, v2
    v_and_b32 v3, 7, v0
    v_lshl_add_u32 v2, v2, 3, v3
    v_lshrrev_b32 v3, 3, v2
    v_lshrrev_b32 v4, 4, v0
    v_cmp_eq_u32 vcc, v3, v4
    v_and_b32 v3, 1, v2
    v_lshlrev_b32 v3, 4, v3
    v_mov_b32 v4, 0x3f80
    v_lshlrev_b32 v3, v3, v4
    v_cndmask_b32 v3, 0, v3, vcc
    v_bfe_u32 v4, v2, 1, 2
    v_cmp_eq_u32 vcc, 0, v4
    s_nop 1
    v_cndmask_b32 v120, 0, v3, vcc
    v_cmp_eq_u32 vcc, 1, v4
    s_nop 1
    v_cndmask_b32 v121, 0, v3, vcc
    v_cmp_eq_u32 vcc, 2, v4
    s_nop 1
    v_cndmask_b32 v122, 0, v3, vcc
    v_cmp_eq_u32 vcc, 3, v4
    s_nop 1
    v_cndmask_b32 v123, 0, v3, vcc
    v_lshrrev_b32 v2, 5, v0
    v_bfe_u32 v3, v0, 4, 1
    v_and_b32 v4, 15, v0
    v_lshlrev_b32 v135, 4, v4
    v_lshl_add_u32 v135, v2, 8, v135
    v_lshl_add_u32 v134, v3, 9, v135
    v_lshl_add_u32 v135, v3, 3, v135
    s_lshl_b32 s73, s86, 9
    v_add_u32 v135, s73, v135
    s_mov_b32 s24, s34
    s_and_b32 s25, s35, 0xffff
    s_mov_b32 s26, 10240
    s_mov_b32 s27, 0x00020000
    v_and_b32 v4, 7, v0
    v_mul_u32_u24 v4, 1280, v4
    v_lshl_add_u32 v4, v2, 5, v4
    v_lshl_add_u32 v4, v3, 4, v4
    v_bfe_u32 v3, v0, 3, 1
    v_lshl_add_u32 v4, v3, 2, v4
    s_lshl_b32 s73, s86, 6
    buffer_load_dword v124, v4, s[24:27], s73 offen
    buffer_load_dword v125, v4, s[24:27], s73 offen offset:8
    s_lshr_b32 s88, s86, 1
    s_lshl_b32 s88, s88, 14
    s_and_b32 s73, s86, 1
    s_lshl_b32 s73, s73, 12
    s_add_u32 s88, s88, s73
    s_add_u32 s88, s88, 4194304
    s_mul_i32 s89, s61, 20
    s_add_u32 s89, s89, s86
    s_lshl_b32 s89, s89, 7
    s_add_u32 s89, s89, 5521408
    s_barrier
    s_barrier
    s_barrier
    s_barrier
    s_cmp_lg_u32 s66, 0
    s_cbranch_scc1 Lgw_skip_5
    s_mov_b32 s73, 16
    v_and_b32 v4, 7, v0
    v_lshlrev_b32 v4, 5, v4
    s_cmp_lg_u32 s71, 0
    s_cbranch_scc1 Lgw_m1_8
Lgw_6:
    buffer_load_dwordx2 v[2:3], v4, s[8:11], 0 offen offset:8 sc1
    s_waitcnt vmcnt(0)
    v_xor_b32 v2, -1, v2
    v_xor_b32 v3, 0x2000, v3
    v_or_b32 v2, v2, v3
    v_cmp_ne_u32 vcc, 0, v2
    s_cbranch_vccnz Lgw_x_9
Lgw_done_7:
    buffer_load_dwordx2 v[2:3], off, s[8:11], s73 sc1
    s_mov_b32 s75, 0
    s_mov_b32 s76, 0
    s_add_u32 m0, s76, 0
    s_add_u32 s77, s75, 0
    buffer_load_dwordx4 v1, s[4:7], s77 offen lds
    buffer_load_dwordx4 v1, s[4:7], s77 offen offset:1024 lds
    buffer_load_dwordx4 v1, s[4:7], s77 offen offset:2048 lds
    buffer_load_dwordx4 v1, s[4:7], s77 offen offset:3072 lds
    s_add_u32 m0, s76, 4096
    s_add_u32 s77, s75, 4096
    buffer_load_dwordx4 v1, s[4:7], s77 offen lds
    buffer_load_dwordx4 v1, s[4:7], s77 offen offset:1024 lds
    buffer_load_dwordx4 v1, s[4:7], s77 offen offset:2048 lds
    buffer_load_dwordx4 v1, s[4:7], s77 offen offset:3072 lds
    s_add_u32 m0, s76, 8192
    s_add_u32 s77, s75, 8192
    buffer_load_dwordx4 v1, s[4:7], s77 offen lds
    buffer_load_dwordx4 v1, s[4:7], s77 offen offset:1024 lds
    buffer_load_dwordx4 v1, s[4:7], s77 offen offset:2048 lds
    buffer_load_dwordx4 v1, s[4:7], s77 offen offset:3072 lds
    s_add_u32 m0, s76, 12288
    s_add_u32 s77, s75, 12288
    buffer_load_dwordx4 v1, s[4:7], s77 offen lds
    buffer_load_dwordx4 v1, s[4:7], s77 offen offset:1024 lds
    buffer_load_dwordx4 v1, s[4:7], s77 offen offset:2048 lds
    buffer_load_dwordx4 v1, s[4:7], s77 offen offset:3072 lds
    s_add_u32 m0, s76, 16384
    s_add_u32 s77, s75, 16384
    buffer_load_dwordx4 v1, s[4:7], s77 offen lds
    buffer_load_dwordx4 v1, s[4:7], s77 offen offset:1024 lds
    buffer_load_dwordx4 v1, s[4:7], s77 offen offset:2048 lds
    buffer_load_dwordx4 v1, s[4:7], s77 offen offset:3072 lds
    s_add_u32 m0, s76, 20480
    s_add_u32 s77, s75, 20480
    buffer_load_dwordx4 v1, s[4:7], s77 offen lds
    buffer_load_dwordx4 v1, s[4:7], s77 offen offset:1024 lds
    buffer_load_dwordx4 v1, s[4:7], s77 offen offset:2048 lds
    buffer_load_dwordx4 v1, s[4:7], s77 offen offset:3072 lds
    s_add_u32 m0, s76, 24576
    s_add_u32 s77, s75, 24576
    buffer_load_dwordx4 v1, s[4:7], s77 offen lds
    buffer_load_dwordx4 v1, s[4:7], s77 offen offset:1024 lds
    buffer_load_dwordx4 v1, s[4:7], s77 offen offset:2048 lds
    buffer_load_dwordx4 v1, s[4:7], s77 offen offset:3072 lds
    s_add_u32 m0, s76, 28672
    s_add_u32 s77, s75, 28672
    buffer_load_dwordx4 v1, s[4:7], s77 offen lds
    buffer_load_dwordx4 v1, s[4:7], s77 offen offset:1024 lds
    buffer_load_dwordx4 v1, s[4:7], s77 offen offset:2048 lds
    buffer_load_dwordx4 v1, s[4:7], s77 offen offset:3072 lds
    s_add_u32 m0, s76, 32768
    s_add_u32 s77, s75, 32768
    buffer_load_dwordx4 v1, s[4:7], s77 offen lds
    buffer_load_dwordx4 v1, s[4:7], s77 offen offset:1024 lds
    buffer_load_dwordx4 v1, s[4:7], s77 offen offset:2048 lds
    buffer_load_dwordx4 v1, s[4:7], s77 offen offset:3072 lds
    s_add_u32 m0, s76, 36864
    s_add_u32 s77, s75, 36864
    buffer_load_dwordx4 v1, s[4:7], s77 offen lds
    buffer_load_dwordx4 v1, s[4:7], s77 offen offset:1024 lds
    buffer_load_dwordx4 v1, s[4:7], s77 offen offset:2048 lds
    buffer_load_dwordx4 v1, s[4:7], s77 offen offset:3072 lds
    s_waitcnt vmcnt(0)
Lgw_r_10:
    v_mov_b32 v4, 163584
    ds_write_b64 v4, v[2:3] offset:32
    s_waitcnt lgkmcnt(0)
Lgw_skip_5:
    s_mov_b32 s64, -1
    s_waitcnt vmcnt(0)
    s_barrier
    v_mov_b32 v2, 163584
    ds_read_b32 v2, v2 offset:32
    s_waitcnt lgkmcnt(0)
    v_readfirstlane_b32 s63, v2
    s_nop 0
    s_cmp_lt_i32 s63, 0
    s_cbranch_scc1 L_redo
    v_mov_b32 v2, 163584
    ds_read_b32 v2, v2 offset:36
    s_waitcnt lgkmcnt(0)
    v_readfirstlane_b32 s72, v2
    s_nop 0
    s_cmp_gt_i32 s72, 0
    s_cselect_b32 s72, 8192, 0
    s_lshl_b32 s77, s61, 11
    s_and_b32 s77, s77, 8192
    s_xor_b32 s72, s72, s77
    s_add_u32 s88, s88, s72
    s_mov_b32 s31, 64
    s_branch L_SA01_dma
L_SA01_loop:
    s_and_b32 s84, s64, 3
    s_mul_i32 s84, s84, 475136
    s_add_u32 s84, s84, s81
    s_add_u32 s85, s64, 2
    s_and_b32 s85, s85, 3
    s_mul_i32 s85, s85, 475136
    s_add_u32 s85, s85, s81
    s_setprio 3
    s_and_b32 s83, s64, 3
    s_mul_i32 s83, s83, 475136
    s_add_u32 s83, s83, s80
    s_cmp_ge_u32 s86, 20
    s_cbranch_scc1 Lc1skip_12
    s_add_u32 s90, s64, 1
    s_and_b32 s90, s90, 3
    s_mul_i32 s90, s90, 327680
    s_add_u32 s90, s90, s88
    v_mov_b32 v3, s64
    s_cmp_eq_u32 s64, 0
    s_cbranch_scc1 Lc1pub_11
    s_mov_b32 exec_hi, 0
    buffer_load_dword v128, v12, s[4:7], s89 offen sc1
    s_nop 11
    buffer_load_dword v129, v12, s[4:7], s89 offen sc1
    s_nop 11
    buffer_load_dword v130, v12, s[4:7], s89 offen sc1
    s_nop 11
Lpoll_13:
    buffer_load_dword v131, v12, s[4:7], s89 offen sc1
    s_waitcnt vmcnt(3)
    v_cmp_gt_i32 vcc, s64, v128
    s_cbranch_vccz Ldone_14
    buffer_load_dword v128, v12, s[4:7], s89 offen sc1
    s_waitcnt vmcnt(3)
    v_cmp_gt_i32 vcc, s64, v129
    s_cbranch_vccz Ldone_14
    buffer_load_dword v129, v12, s[4:7], s89 offen sc1
    s_waitcnt vmcnt(3)
    v_cmp_gt_i32 vcc, s64, v130
    s_cbranch_vccz Ldone_14
    buffer_load_dword v130, v12, s[4:7], s89 offen sc1
    s_waitcnt vmcnt(3)
    v_cmp_gt_i32 vcc, s64, v131
    s_cbranch_vccz Ldone_14
    s_sub_u32 s65, s65, 1
    s_cbranch_scc0 Lpoll_13
    s_mov_b32 s65, 0
Ldone_14:
    s_mov_b32 exec_hi, -1
    s_sleep 8
    s_add_u32 s74, s90, 163840
    buffer_load_dwordx4 v[88:91], v134, s[4:7], s74 offen offset:0 sc1
    buffer_load_dwordx4 v[92:95], v134, s[4:7], s74 offen offset:1024 sc1
    buffer_load_dwordx4 v[96:99], v134, s[4:7], s74 offen offset:2048 sc1
    buffer_load_dwordx4 v[100:103], v134, s[4:7], s74 offen offset:3072 sc1
    s_sleep 4
    buffer_load_dwordx4 v[56:59], v134, s[4:7], s90 offen offset:0 sc1
    buffer_load_dwordx4 v[60:63], v134, s[4:7], s90 offen offset:1024 sc1
    buffer_load_dwordx4 v[64:67], v134, s[4:7], s90 offen offset:2048 sc1
    buffer_load_dwordx4 v[68:71], v134, s[4:7], s90 offen offset:3072 sc1
    s_waitcnt vmcnt(4)
    v_mfma_f32_16x16x32_bf16 v[124:127], v[120:123], v[88:91], 0
    v_max3_u32 v2, v88, v89, v90
    v_mfma_f32_16x16x32_bf16 v[124:127], v[120:123], v[92:95], v[124:127]
    v_max3_u32 v2, v2, v91, v92
    v_mfma_f32_16x16x32_bf16 v[124:127], v[120:123], v[96:99], v[124:127]
    v_max3_u32 v2, v2, v93, v94
    v_mfma_f32_16x16x32_bf16 v[124:127], v[120:123], v[100:103], v[124:127]
    v_max3_u32 v2, v2, v95, v96
    v_max3_u32 v2, v2, v97, v98
    v_max3_u32 v2, v2, v99, v100
    v_max3_u32 v2, v2, v101, v102
    v_max_u32 v2, v2, v103
    v_cmp_eq_u32 vcc, -1, v2
    s_cbranch_vccz Lpd_15
Lpoll_16:
    buffer_load_dwordx4 v[72:75], v134, s[4:7], s90 offen offset:0 sc1
    buffer_load_dwordx4 v[76:79], v134, s[4:7], s90 offen offset:1024 sc1
    buffer_load_dwordx4 v[80:83], v134, s[4:7], s90 offen offset:2048 sc1
    buffer_load_dwordx4 v[84:87], v134, s[4:7], s90 offen offset:3072 sc1
    s_waitcnt vmcnt(4)
    v_mfma_f32_16x16x32_bf16 v[124:127], v[120:123], v[56:59], 0
    v_max3_u32 v2, v56, v57, v58
    v_mfma_f32_16x16x32_bf16 v[124:127], v[120:123], v[60:63], v[124:127]
    v_max3_u32 v2, v2, v59, v60
    v_mfma_f32_16x16x32_bf16 v[124:127], v[120:123], v[64:67], v[124:127]
    v_max3_u32 v2, v2, v61, v62
    v_mfma_f32_16x16x32_bf16 v[124:127], v[120:123], v[68:71], v[124:127]
    v_max3_u32 v2, v2, v63, v64
    v_max3_u32 v2, v2, v65, v66
    v_max3_u32 v2, v2, v67, v68
    v_max3_u32 v2, v2, v69, v70
    v_max_u32 v2, v2, v71
    v_cmp_eq_u32 vcc, -1, v2
    s_cbranch_vccz Lpd_15
    buffer_load_dwordx4 v[56:59], v134, s[4:7], s90 offen offset:0 sc1
    buffer_load_dwordx4 v[60:63], v134, s[4:7], s90 offen offset:1024 sc1
    buffer_load_dwordx4 v[64:67], v134, s[4:7], s90 offen offset:2048 sc1
    buffer_load_dwordx4 v[68:71], v134, s[4:7], s90 offen offset:3072 sc1
    s_waitcnt vmcnt(4)
    v_mfma_f32_16x16x32_bf16 v[124:127], v[120:123], v[72:75], 0
    v_max3_u32 v2, v72, v73, v74
    v_mfma_f32_16x16x32_bf16 v[124:127], v[120:123], v[76:79], v[124:127]
    v_max3_u32 v2, v2, v75, v76
    v_mfma_f32_16x16x32_bf16 v[124:127], v[120:123], v[80:83], v[124:127]
    v_max3_u32 v2, v2, v77, v78
    v_mfma_f32_16x16x32_bf16 v[124:127], v[120:123], v[84:87], v[124:127]
    v_max3_u32 v2, v2, v79, v80
    v_max3_u32 v2, v2, v81, v82
    v_max3_u32 v2, v2, v83, v84
    v_max3_u32 v2, v2, v85, v86
    v_max_u32 v2, v2, v87
    v_cmp_eq_u32 vcc, -1, v2
    s_cbranch_vccz Lpd_15
    s_sub_u32 s65, s65, 1
    s_cbranch_scc0 Lpoll_16
    s_mov_b32 s65, 0
Lpd_15:
    s_nop 0
    v_cvt_pk_bf16_f32 v124, v124, v125
    v_cvt_pk_bf16_f32 v125, v126, v127
Lc1pub_11:
    v_min_u32 v124, -2, v124
    v_min_u32 v125, -2, v125
    buffer_store_dwordx2 v[124:125], v135, s[4:7], s83 offen
    s_cmp_lg_u32 s63, 0
    s_cbranch_scc1 Lslow_17
Lback_18:
    ds_write_b32 v13, v3
Lc1skip_12:
Lflag_19:
    ds_read_b32 v2, v13
    s_waitcnt lgkmcnt(0)
    v_cmp_gt_i32 vcc, s64, v2
    s_cbranch_vccz Lflagd_20
    s_sleep 1
    s_branch Lflag_19
Lflagd_20:
    buffer_load_dwordx4 v[16:19], v5, s[4:7], s83 offen offset:0 sc1
    buffer_load_dwordx4 v[20:23], v5, s[4:7], s83 offen offset:1024 sc1
    s_sleep 2
Lpoll_21:
    buffer_load_dwordx4 v[24:27], v5, s[4:7], s83 offen offset:0 sc1
    buffer_load_dwordx4 v[28:31], v5, s[4:7], s83 offen offset:1024 sc1
    s_waitcnt vmcnt(2)
    ds_write_b128 v6, v[16:19] offset:0
    ds_write_b128 v6, v[20:23] offset:1024
    v_max3_u32 v2, v16, v17, v18
    v_max3_u32 v2, v2, v19, v20
    v_max3_u32 v2, v2, v21, v22
    v_max_u32 v2, v2, v23
    v_cmp_eq_u32 vcc, -1, v2
    s_cbranch_vccz Ldone_22
    buffer_load_dwordx4 v[16:19], v5, s[4:7], s83 offen offset:0 sc1
    buffer_load_dwordx4 v[20:23], v5, s[4:7], s83 offen offset:1024 sc1
    s_waitcnt vmcnt(2)
    ds_write_b128 v6, v[24:27] offset:0
    ds_write_b128 v6, v[28:31] offset:1024
    v_max3_u32 v2, v24, v25, v26
    v_max3_u32 v2, v2, v27, v28
    v_max3_u32 v2, v2, v29, v30
    v_max_u32 v2, v2, v31
    v_cmp_eq_u32 vcc, -1, v2
    s_cbranch_vccz Ldone_22
    s_sub_u32 s65, s65, 1
    s_cbranch_scc0 Lpoll_21
    s_mov_b32 s65, 0
Ldone_22:
    s_waitcnt lgkmcnt(0)
    s_barrier
    s_setprio 0
    ds_read_b128 v[40:43], v8 offset:8192
    ds_read_b128 v[44:47], v8 offset:9216
    buffer_store_dword v52, v9, s[4:7], s85 offen
    s_cmp_lg_u32 s63, 0
    s_cbranch_scc1 Lslow_23
Lback_24:
    s_cmp_ge_u32 s86, 20
    s_cbranch_scc1 L_SA01_nor
    s_add_u32 s74, s64, 2
    s_and_b32 s74, s74, 3
    s_mul_i32 s74, s74, 475136
    s_add_u32 s74, s74, s80
    buffer_store_dwordx2 v[52:53], v135, s[4:7], s74 offen
    s_cmp_lg_u32 s63, 0
    s_cbranch_scc1 Lslow_25
Lback_26:
L_SA01_nor:
    v_xor_b32 v8, 4096, v8
    s_setprio 3
    s_waitcnt lgkmcnt(0)
    s_barrier
    ds_read_b64_tr_b16 v[32:33], v7 offset:0
    ds_read_b64_tr_b16 v[34:35], v7 offset:32
    ds_read_b64_tr_b16 v[36:37], v7 offset:256
    ds_read_b64_tr_b16 v[38:39], v7 offset:288
    s_waitcnt lgkmcnt(2)
    v_mfma_f32_16x16x32_bf16 v[48:51], v[32:35], v[40:43], 0
    s_waitcnt lgkmcnt(0)
    v_mfma_f32_16x16x32_bf16 v[48:51], v[36:39], v[44:47], v[48:51]
    s_nop 7
    v_mul_f32 v50, s70, v50
    v_mul_f32 v51, s70, v51
    v_cvt_pk_bf16_f32 v48, v50, v51
    v_min_u32 v48, -2, v48
    buffer_store_dword v48, v9, s[4:7], s84 offen
    s_cmp_lg_u32 s63, 0
    s_cbranch_scc1 Lslow_27
Lback_28:
    s_sleep 1
L_SA01_dma:
    s_add_u32 m0, s29, 0
    s_add_u32 s77, s28, 0
    buffer_load_dwordx4 v1, s[4:7], s77 offen lds
    buffer_load_dwordx4 v1, s[4:7], s77 offen offset:1024 lds
    buffer_load_dwordx4 v1, s[4:7], s77 offen offset:2048 lds
    buffer_load_dwordx4 v1, s[4:7], s77 offen offset:3072 lds
    s_add_u32 m0, s29, 4096
    s_add_u32 s77, s28, 4096
    buffer_load_dwordx4 v1, s[4:7], s77 offen lds
    buffer_load_dwordx4 v1, s[4:7], s77 offen offset:1024 lds
    buffer_load_dwordx4 v1, s[4:7], s77 offen offset:2048 lds
    buffer_load_dwordx4 v1, s[4:7], s77 offen offset:3072 lds
    s_add_u32 m0, s29, 8192
    s_add_u32 s77, s28, 8192
    buffer_load_dwordx4 v1, s[4:7], s77 offen lds
    buffer_load_dwordx4 v1, s[4:7], s77 offen offset:1024 lds
    buffer_load_dwordx4 v1, s[4:7], s77 offen offset:2048 lds
    buffer_load_dwordx4 v1, s[4:7], s77 offen offset:3072 lds
    s_add_u32 m0, s29, 12288
    s_add_u32 s77, s28, 12288
    buffer_load_dwordx4 v1, s[4:7], s77 offen lds
    buffer_load_dwordx4 v1, s[4:7], s77 offen offset:1024 lds
    buffer_load_dwordx4 v1, s[4:7], s77 offen offset:2048 lds
    buffer_load_dwordx4 v1, s[4:7], s77 offen offset:3072 lds
    s_add_u32 m0, s29, 16384
    s_add_u32 s77, s28, 16384
    buffer_load_dwordx4 v1, s[4:7], s77 offen lds
    buffer_load_dwordx4 v1, s[4:7], s77 offen offset:1024 lds
    buffer_load_dwordx4 v1, s[4:7], s77 offen offset:2048 lds
    buffer_load_dwordx4 v1, s[4:7], s77 offen offset:3072 lds
    s_add_u32 s28, s28, 40960
    s_sub_u32 s29, s30, s29
L_SA01_next:
    s_add_u32 s64, s64, 1
    s_cmp_lt_i32 s64, 64
    s_cbranch_scc1 L_SA01_loop
    s_endpgm
L_SA23:
    s_sub_u32 s87, s66, 2
    s_mul_i32 s73, s87, 1024
    s_add_u32 s73, s73, 8192
    v_add_u32 v5, s73, v1
    v_add_u32 v6, 81920, v5
    v_and_b32 v9, 15, v0
    v_lshlrev_b32 v9, 4, v9
    v_lshl_add_u32 v9, v2, 2, v9
    s_and_b32 s73, s68, 1
    s_lshl_b32 s73, s73, 9
    s_lshr_b32 s74, s68, 1
    s_lshl_b32 s74, s74, 5
    s_add_u32 s73, s73, s74
    s_add_u32 s73, s73, 1280
    v_add_u32 v9, s73, v9
    s_sub_u32 s87, s66, 2
    v_and_b32 v10, 15, v0
    s_lshl_b32 s73, s87, 4
    v_add_u32 v10, s73, v10
    v_lshlrev_b32 v4, 2, v2
    v_sub_u32 v10, v10, v4
    s_lshl_b32 s82, s67, 1
    s_add_u32 s82, s82, s87
    s_mul_i32 s86, s82, 1280
    s_add_u32 s86, s86, 16777216
    s_mul_i32 s82, s82, 5120
    s_add_u32 s82, s82, 5710848
    s_cmp_eq_u32 s68, 2
    s_cselect_b32 s73, 2560, 0
    s_add_u32 s82, s82, s73
    s_lshl_b32 s90, s67, 1
    s_add_u32 s90, s90, s68
    s_mul_i32 s90, s90, 5120
    s_add_u32 s90, s90, 5710848
    s_lshl_b32 s73, s87, 10
    v_add_u32 v142, s73, v1
    s_mov_b32 s20, s48
    s_and_b32 s21, s49, 0xffff
    s_mov_b32 s22, 1966080
    s_mov_b32 s23, 0x00020000
    s_mul_i32 s28, s61, 384
    s_lshl_b32 s73, s69, 5
    s_add_u32 s28, s28, s73
    s_mul_i32 s73, s87, 983040
    s_add_u32 s28, s28, s73
    s_mul_i32 s91, s87, 10240
    v_lshrrev_b32 v2, 1, v0
    v_mul_u32_u24 v2, 3072, v2
    v_and_b32 v3, 1, v0
    v_lshl_add_u32 v2, v3, 4, v2
    s_add_u32 m0, s91, 139264
    s_add_u32 s72, s28, 0
    buffer_load_dwordx4 v2, s[20:23], s72 offen lds
    s_add_u32 m0, s91, 140288
    s_add_u32 s72, s28, 98304
    buffer_load_dwordx4 v2, s[20:23], s72 offen lds
    s_add_u32 m0, s91, 141312
    s_add_u32 s72, s28, 196608
    buffer_load_dwordx4 v2, s[20:23], s72 offen lds
    s_add_u32 m0, s91, 142336
    s_add_u32 s72, s28, 294912
    buffer_load_dwordx4 v2, s[20:23], s72 offen lds
    s_add_u32 m0, s91, 143360
    s_add_u32 s72, s28, 393216
    buffer_load_dwordx4 v2, s[20:23], s72 offen lds
    s_add_u32 m0, s91, 144384
    s_add_u32 s72, s28, 491520
    buffer_load_dwordx4 v2, s[20:23], s72 offen lds
    s_add_u32 m0, s91, 145408
    s_add_u32 s72, s28, 589824
    buffer_load_dwordx4 v2, s[20:23], s72 offen lds
    s_add_u32 m0, s91, 146432
    s_add_u32 s72, s28, 688128
    buffer_load_dwordx4 v2, s[20:23], s72 offen lds
    s_add_u32 m0, s91, 147456
    s_add_u32 s72, s28, 786432
    buffer_load_dwordx4 v2, s[20:23], s72 offen lds
    s_add_u32 m0, s91, 148480
    s_add_u32 s72, s28, 884736
    buffer_load_dwordx4 v2, s[20:23], s72 offen lds
    v_and_b32 v2, 15, v0
    v_lshlrev_b32 v2, 3, v2
    v_lshrrev_b32 v3, 4, v0
    v_lshl_add_u32 v2, v3, 8, v2
    v_add_u32 v2, 139264, v2
    s_barrier
    s_barrier
    s_barrier
    s_waitcnt vmcnt(0)
    s_barrier
    ds_read_b64_tr_b16 v[144:145], v2 offset:0
    ds_read_b64_tr_b16 v[146:147], v2 offset:128
    ds_read_b64_tr_b16 v[148:149], v2 offset:1024
    ds_read_b64_tr_b16 v[150:151], v2 offset:1152
    ds_read_b64_tr_b16 v[152:153], v2 offset:2048
    ds_read_b64_tr_b16 v[154:155], v2 offset:2176
    ds_read_b64_tr_b16 v[156:157], v2 offset:3072
    ds_read_b64_tr_b16 v[158:159], v2 offset:3200
    ds_read_b64_tr_b16 v[160:161], v2 offset:4096
    ds_read_b64_tr_b16 v[162:163], v2 offset:4224
    ds_read_b64_tr_b16 v[164:165], v2 offset:5120
    ds_read_b64_tr_b16 v[166:167], v2 offset:5248
    ds_read_b64_tr_b16 v[168:169], v2 offset:6144
    ds_read_b64_tr_b16 v[170:171], v2 offset:6272
    ds_read_b64_tr_b16 v[172:173], v2 offset:7168
    ds_read_b64_tr_b16 v[174:175], v2 offset:7296
    ds_read_b64_tr_b16 v[176:177], v2 offset:8192
    ds_read_b64_tr_b16 v[178:179], v2 offset:8320
    ds_read_b64_tr_b16 v[180:181], v2 offset:9216
    ds_read_b64_tr_b16 v[182:183], v2 offset:9344
    ds_read_b64_tr_b16 v[184:185], v2 offset:10240
    ds_read_b64_tr_b16 v[186:187], v2 offset:10368
    ds_read_b64_tr_b16 v[188:189], v2 offset:11264
    ds_read_b64_tr_b16 v[190:191], v2 offset:11392
    ds_read_b64_tr_b16 v[192:193], v2 offset:12288
    ds_read_b64_tr_b16 v[194:195], v2 offset:12416
    ds_read_b64_tr_b16 v[196:197], v2 offset:13312
    ds_read_b64_tr_b16 v[198:199], v2 offset:13440
    ds_read_b64_tr_b16 v[200:201], v2 offset:14336
    ds_read_b64_tr_b16 v[202:203], v2 offset:14464
    ds_read_b64_tr_b16 v[204:205], v2 offset:15360
    ds_read_b64_tr_b16 v[206:207], v2 offset:15488
    ds_read_b64_tr_b16 v[208:209], v2 offset:16384
    ds_read_b64_tr_b16 v[210:211], v2 offset:16512
    ds_read_b64_tr_b16 v[212:213], v2 offset:17408
    ds_read_b64_tr_b16 v[214:215], v2 offset:17536
    ds_read_b64_tr_b16 v[216:217], v2 offset:18432
    ds_read_b64_tr_b16 v[218:219], v2 offset:18560
    ds_read_b64_tr_b16 v[220:221], v2 offset:19456
    ds_read_b64_tr_b16 v[222:223], v2 offset:19584
    s_waitcnt lgkmcnt(0)
    s_lshl_b32 s28, s61, 1
    s_add_u32 s28, s28, s87
    s_mul_i32 s28, s28, 6
    s_lshr_b32 s73, s69, 1
    s_add_u32 s28, s28, s73
    s_lshl_b32 s28, s28, 10
    s_and_b32 s73, s69, 1
    s_lshl_b32 s73, s73, 3
    s_add_u32 s28, s28, s73
    s_add_u32 s28, s28, 8388608
    s_mov_b32 s29, 0xbfb8aa3b
    s_mov_b32 s64, -1
    s_barrier
    v_mov_b32 v2, 163584
    ds_read_b32 v2, v2 offset:32
    s_waitcnt lgkmcnt(0)
    v_readfirstlane_b32 s63, v2
    s_nop 0
    s_cmp_lt_i32 s63, 0
    s_cbranch_scc1 L_redo
    s_setprio 1
    s_branch L_SA23_ffn
L_SA23_loop:
    s_and_b32 s83, s64, 3
    s_mul_i32 s83, s83, 475136
    s_add_u32 s83, s83, s80
    s_and_b32 s84, s64, 3
    s_mul_i32 s84, s84, 475136
    s_add_u32 s84, s84, s81
    s_add_u32 s85, s64, 2
    s_and_b32 s85, s85, 3
    s_mul_i32 s85, s85, 475136
    s_add_u32 s85, s85, s81
    s_add_u32 s88, s64, 3
    s_and_b32 s88, s88, 3
    s_mul_i32 s88, s88, 475136
    s_add_u32 s88, s88, s82
    s_add_u32 s89, s88, 2560
    v_mov_b32 v80, v92
    v_mov_b32 v81, v93
    v_mov_b32 v82, v94
    v_mov_b32 v83, v95
    v_mov_b32 v84, v96
    v_mov_b32 v85, v97
    v_mov_b32 v86, v98
    v_mov_b32 v87, v99
    v_mov_b32 v88, v100
    v_mov_b32 v89, v101
    s_setprio 3
Lflag_29:
    ds_read_b32 v2, v13
    s_waitcnt lgkmcnt(0)
    v_cmp_gt_i32 vcc, s64, v2
    s_cbranch_vccz Lflagd_30
    s_sleep 1
    s_branch Lflag_29
Lflagd_30:
    buffer_load_dwordx4 v[16:19], v5, s[4:7], s83 offen offset:0 sc1
    s_sleep 2
Lpoll_31:
    buffer_load_dwordx4 v[20:23], v5, s[4:7], s83 offen offset:0 sc1
    s_waitcnt vmcnt(1)
    ds_write_b128 v6, v[16:19] offset:0
    v_max3_u32 v2, v16, v17, v18
    v_max_u32 v2, v2, v19
    v_cmp_eq_u32 vcc, -1, v2
    s_cbranch_vccz Ldone_32
    buffer_load_dwordx4 v[16:19], v5, s[4:7], s83 offen offset:0 sc1
    s_waitcnt vmcnt(1)
    ds_write_b128 v6, v[20:23] offset:0
    v_max3_u32 v2, v20, v21, v22
    v_max_u32 v2, v2, v23
    v_cmp_eq_u32 vcc, -1, v2
    s_cbranch_vccz Ldone_32
    s_sub_u32 s65, s65, 1
    s_cbranch_scc0 Lpoll_31
    s_mov_b32 s65, 0
Ldone_32:
    s_waitcnt lgkmcnt(0)
    s_barrier
    s_setprio 0
    s_lshl_b32 s73, s87, 11
    v_add_u32 v2, s73, v8
    ds_read_b128 v[56:59], v2
    ds_read_b128 v[60:63], v2 offset:1024
    ds_read_b128 v[64:67], v8 offset:8192
    ds_read_b128 v[68:71], v8 offset:9216
    ds_read_b128 v[72:75], v8 offset:10240
    ds_read_b128 v[76:79], v8 offset:11264
    s_cmp_lg_u32 s68, s87
    s_cbranch_scc1 L_SA23_noxl
    buffer_load_dwordx4 v[104:107], v1, s[4:7], s88 offen sc1
    buffer_load_dwordx4 v[108:111], v1, s[4:7], s88 offen offset:1024 sc1
    buffer_load_dwordx2 v[112:113], v11, s[4:7], s88 offen offset:2048 sc1
    buffer_load_dwordx4 v[116:119], v1, s[4:7], s89 offen sc1
    buffer_load_dwordx4 v[120:123], v1, s[4:7], s89 offen offset:1024 sc1
    buffer_load_dwordx2 v[124:125], v11, s[4:7], s89 offen offset:2048 sc1
    s_branch L_SA23_noxr
L_SA23_noxl:
    s_cmp_eq_u32 s68, 2
    s_cbranch_scc1 L_SA23_noxr
    s_add_u32 s74, s64, 2
    s_and_b32 s74, s74, 3
    s_mul_i32 s74, s74, 475136
    s_add_u32 s74, s74, s90
    s_add_u32 s75, s74, 4096
    buffer_store_dwordx4 v[52:55], v1, s[4:7], s74 offen offset:0
    buffer_store_dwordx4 v[52:55], v1, s[4:7], s74 offen offset:1024
    buffer_store_dwordx4 v[52:55], v1, s[4:7], s74 offen offset:2048
    buffer_store_dwordx4 v[52:55], v1, s[4:7], s74 offen offset:3072
    buffer_store_dwordx4 v[52:55], v1, s[4:7], s75 offen
    s_cmp_lg_u32 s63, 0
    s_cbranch_scc1 Lslow_33
Lback_34:
L_SA23_noxr:
    s_and_b32 s83, s64, 3
    s_mul_i32 s83, s83, 475136
    s_add_u32 s83, s83, s82
    s_cmp_eq_u32 s66, 3
    s_cbranch_scc1 L_SA23_nors
    s_mov_b64 exec, s[92:93]
    buffer_store_dword v52, v9, s[4:7], s85 offen
    s_cmp_lg_u32 s63, 0
    s_cbranch_scc1 Lslow_35
Lback_36:
    s_mov_b64 exec, -1
L_SA23_nors:
    s_setprio 3
    s_cmp_eq_u32 s66, 3
    s_waitcnt lgkmcnt(0)
    s_barrier
    ds_read_b64_tr_b16 v[32:33], v7 offset:0
    ds_read_b64_tr_b16 v[34:35], v7 offset:32
    ds_read_b64_tr_b16 v[36:37], v7 offset:256
    ds_read_b64_tr_b16 v[38:39], v7 offset:288
    s_cbranch_scc1 L_SA23_x
    s_waitcnt lgkmcnt(2)
    v_mfma_f32_16x16x32_bf16 v[48:51], v[32:35], v[32:35], 0
    s_waitcnt lgkmcnt(0)
    v_mfma_f32_16x16x32_bf16 v[48:51], v[36:39], v[36:39], v[48:51]
    s_mov_b64 exec, s[92:93]
    s_nop 6
    v_mul_f32 v50, s70, v50
    v_mul_f32 v51, s70, v51
    v_cvt_pk_bf16_f32 v48, v50, v51
    v_min_u32 v48, -2, v48
    buffer_store_dword v48, v9, s[4:7], s84 offen
    s_cmp_lg_u32 s63, 0
    s_cbranch_scc1 Lslow_37
Lback_38:
    s_mov_b64 exec, -1
L_SA23_x:
    s_setprio 1
    s_waitcnt lgkmcnt(0)
    v_mfma_f32_16x16x32_bf16 v[92:95], v[64:67], v[56:59], 0
    v_mfma_f32_16x16x32_bf16 v[96:99], v[72:75], v[56:59], 0
    v_mfma_f32_16x16x32_bf16 v[100:103], v[32:35], v[56:59], 0
    v_mfma_f32_16x16x32_bf16 v[92:95], v[68:71], v[60:63], v[92:95]
    v_mfma_f32_16x16x32_bf16 v[96:99], v[76:79], v[60:63], v[96:99]
    v_mfma_f32_16x16x32_bf16 v[100:103], v[36:39], v[60:63], v[100:103]
    v_xor_b32 v8, 4096, v8
    s_cmp_eq_u32 s68, s87
    s_cbranch_scc1 L_SA23_own
    s_nop 2
    v_min_u32 v92, -2, v92
    v_min_u32 v93, -2, v93
    v_min_u32 v94, -2, v94
    v_min_u32 v95, -2, v95
    v_min_u32 v96, -2, v96
    v_min_u32 v97, -2, v97
    v_min_u32 v98, -2, v98
    v_min_u32 v99, -2, v99
    v_min_u32 v100, -2, v100
    v_min_u32 v101, -2, v101
    buffer_store_dwordx4 v[92:95], v1, s[4:7], s83 offen
    buffer_store_dwordx4 v[96:99], v1, s[4:7], s83 offen offset:1024
    buffer_store_dwordx2 v[100:101], v11, s[4:7], s83 offen offset:2048
    s_cmp_lg_u32 s63, 0
    s_cbranch_scc1 Lslow_39
Lback_40:
    s_branch L_SA23_ffn
L_SA23_own:
    s_cmp_eq_u32 s64, 0
    s_cbranch_scc1 L_SA23_ffn0
    s_waitcnt vmcnt(0)
    v_max3_u32 v2, v104, v105, v106
    v_max3_u32 v2, v2, v107, v108
    v_max3_u32 v2, v2, v109, v110
    v_max3_u32 v2, v2, v111, v112
    v_max3_u32 v2, v2, v113, v116
    v_max3_u32 v2, v2, v117, v118
    v_max3_u32 v2, v2, v119, v120
    v_max3_u32 v2, v2, v121, v122
    v_max3_u32 v2, v2, v123, v124
    v_max_u32 v2, v2, v125
    v_cmp_eq_u32 vcc, -1, v2
    s_cbranch_vccz L_SA23_got
Lpoll_41:
    buffer_load_dwordx4 v[104:107], v1, s[4:7], s88 offen sc1
    buffer_load_dwordx4 v[108:111], v1, s[4:7], s88 offen offset:1024 sc1
    buffer_load_dwordx2 v[112:113], v11, s[4:7], s88 offen offset:2048 sc1
    buffer_load_dwordx4 v[116:119], v1, s[4:7], s89 offen sc1
    buffer_load_dwordx4 v[120:123], v1, s[4:7], s89 offen offset:1024 sc1
    buffer_load_dwordx2 v[124:125], v11, s[4:7], s89 offen offset:2048 sc1
    s_waitcnt vmcnt(0)
    v_max3_u32 v2, v104, v105, v106
    v_max3_u32 v2, v2, v107, v108
    v_max3_u32 v2, v2, v109, v110
    v_max3_u32 v2, v2, v111, v112
    v_max3_u32 v2, v2, v113, v116
    v_max3_u32 v2, v2, v117, v118
    v_max3_u32 v2, v2, v119, v120
    v_max3_u32 v2, v2, v121, v122
    v_max3_u32 v2, v2, v123, v124
    v_max_u32 v2, v2, v125
    v_cmp_eq_u32 vcc, -1, v2
    s_cbranch_vccnz Lretry_42
Ldone_43:
L_SA23_got:
    v_add_f32 v80, v80, v104
    v_add_f32 v81, v81, v105
    v_add_f32 v82, v82, v106
    v_add_f32 v83, v83, v107
    v_add_f32 v84, v84, v108
    v_add_f32 v85, v85, v109
    v_add_f32 v86, v86, v110
    v_add_f32 v87, v87, v111
    v_add_f32 v88, v88, v112
    v_add_f32 v89, v89, v113
    v_add_f32 v80, v80, v116
    v_add_f32 v81, v81, v117
    v_add_f32 v82, v82, v118
    v_add_f32 v83, v83, v119
    v_add_f32 v84, v84, v120
    v_add_f32 v85, v85, v121
    v_add_f32 v86, v86, v122
    v_add_f32 v87, v87, v123
    v_add_f32 v88, v88, v124
    v_add_f32 v89, v89, v125
    v_mov_b32 v3, 0xff800000
    v_cmp_le_i32 vcc, 0, v10
    s_nop 1
    v_cndmask_b32 v80, v3, v80, vcc
    v_cmp_le_i32 vcc, 1, v10
    s_nop 1
    v_cndmask_b32 v81, v3, v81, vcc
    v_cmp_le_i32 vcc, 2, v10
    s_nop 1
    v_cndmask_b32 v82, v3, v82, vcc
    v_cmp_le_i32 vcc, 3, v10
    s_nop 1
    v_cndmask_b32 v83, v3, v83, vcc
    v_cmp_le_i32 vcc, 16, v10
    s_nop 1
    v_cndmask_b32 v84, v3, v84, vcc
    v_cmp_le_i32 vcc, 17, v10
    s_nop 1
    v_cndmask_b32 v85, v3, v85, vcc
    v_cmp_le_i32 vcc, 18, v10
    s_nop 1
    v_cndmask_b32 v86, v3, v86, vcc
    v_cmp_le_i32 vcc, 19, v10
    s_nop 1
    v_cndmask_b32 v87, v3, v87, vcc
    v_max3_f32 v140, v80, v81, v82
    v_max3_f32 v140, v140, v83, v84
    v_max3_f32 v140, v140, v85, v86
    v_max3_f32 v140, v140, v87, v88
    v_max_f32 v140, v140, v89
    v_mov_b32 v141, v140
    s_nop 1
    v_permlane16_swap_b32 v140, v141
    v_max_f32 v140, v140, v141
    v_mov_b32 v141, v140
    s_nop 1
    v_permlane32_swap_b32 v140, v141
    v_max_f32 v140, v140, v141
    v_sub_f32 v128, v80, v140
    v_sub_f32 v129, v81, v140
    v_sub_f32 v130, v82, v140
    v_sub_f32 v131, v83, v140
    v_sub_f32 v132, v84, v140
    v_sub_f32 v133, v85, v140
    v_sub_f32 v134, v86, v140
    v_sub_f32 v135, v87, v140
    v_sub_f32 v136, v88, v140
    v_sub_f32 v137, v89, v140
    v_mul_f32 v128, s70, v128
    v_mul_f32 v129, s70, v129
    v_mul_f32 v130, s70, v130
    v_mul_f32 v131, s70, v131
    v_mul_f32 v132, s70, v132
    v_mul_f32 v133, s70, v133
    v_mul_f32 v134, s70, v134
    v_mul_f32 v135, s70, v135
    v_mul_f32 v136, s70, v136
    v_mul_f32 v137, s70, v137
    v_exp_f32 v128, v128
    v_exp_f32 v129, v129
    v_exp_f32 v130, v130
    v_exp_f32 v131, v131
    v_exp_f32 v132, v132
    v_exp_f32 v133, v133
    v_exp_f32 v134, v134
    v_exp_f32 v135, v135
    v_exp_f32 v136, v136
    v_exp_f32 v137, v137
    v_add_f32 v140, v128, v129
    v_add_f32 v140, v140, v130
    v_add_f32 v140, v140, v131
    v_add_f32 v140, v140, v132
    v_add_f32 v140, v140, v133
    v_add_f32 v140, v140, v134
    v_add_f32 v140, v140, v135
    v_add_f32 v140, v140, v136
    v_add_f32 v140, v140, v137
    v_mov_b32 v141, v140
    s_nop 1
    v_permlane16_swap_b32 v140, v141
    v_add_f32 v140, v140, v141
    v_mov_b32 v141, v140
    s_nop 1
    v_permlane32_swap_b32 v140, v141
    v_add_f32 v140, v140, v141
    v_rcp_f32 v140, v140
    s_nop 0
    v_mul_f32 v128, v128, v140
    v_mul_f32 v129, v129, v140
    v_mul_f32 v130, v130, v140
    v_mul_f32 v131, v131, v140
    v_mul_f32 v132, v132, v140
    v_mul_f32 v133, v133, v140
    v_mul_f32 v134, v134, v140
    v_mul_f32 v135, v135, v140
    v_mul_f32 v136, v136, v140
    v_mul_f32 v137, v137, v140
    v_cvt_pk_bf16_f32 v80, v128, v129
    v_cvt_pk_bf16_f32 v81, v130, v131
    v_cvt_pk_bf16_f32 v82, v132, v133
    v_cvt_pk_bf16_f32 v83, v134, v135
    v_cvt_pk_bf16_f32 v84, v136, v137
    s_add_u32 s74, s64, 3
    s_and_b32 s74, s74, 3
    s_mul_i32 s74, s74, 81920
    s_add_u32 s74, s74, s86
    buffer_store_dwordx4 v[80:83], v1, s[4:7], s74 offen
    buffer_store_dword v84, v12, s[4:7], s74 offen offset:1024
    s_cmp_lg_u32 s63, 0
    s_cbranch_scc1 Lslow_44
Lback_45:
    s_branch L_SA23_ffn
L_SA23_ffn0:
    s_waitcnt vmcnt(0)
L_SA23_ffn:
    s_cmp_ge_i32 s64, 63
    s_cbranch_scc1 L_SA23_next
    ds_read_b128 v[104:107], v142 offset:0
    ds_read_b128 v[108:111], v142 offset:2048
    ds_read_b128 v[112:115], v142 offset:4096
    ds_read_b128 v[116:119], v142 offset:6144
    ds_read_b128 v[120:123], v142 offset:8192
    ds_read_b128 v[124:127], v142 offset:10240
    ds_read_b128 v[128:131], v142 offset:12288
    ds_read_b128 v[132:135], v142 offset:14336
    s_waitcnt lgkmcnt(7)
    v_mfma_f32_16x16x32_bf16 v[80:83], v[144:147], v[104:107], 0
    ds_read_b128 v[104:107], v142 offset:16384
    s_waitcnt lgkmcnt(7)
    v_mfma_f32_16x16x32_bf16 v[80:83], v[148:151], v[108:111], v[80:83]
    ds_read_b128 v[108:111], v142 offset:18432
    s_waitcnt lgkmcnt(7)
    v_mfma_f32_16x16x32_bf16 v[80:83], v[152:155], v[112:115], v[80:83]
    ds_read_b128 v[112:115], v142 offset:20480
    s_waitcnt lgkmcnt(7)
    v_mfma_f32_16x16x32_bf16 v[80:83], v[156:159], v[116:119], v[80:83]
    ds_read_b128 v[116:119], v142 offset:22528
    s_waitcnt lgkmcnt(7)
    v_mfma_f32_16x16x32_bf16 v[80:83], v[160:163], v[120:123], v[80:83]
    ds_read_b128 v[120:123], v142 offset:24576
    s_waitcnt lgkmcnt(7)
    v_mfma_f32_16x16x32_bf16 v[80:83], v[164:167], v[124:127], v[80:83]
    ds_read_b128 v[124:127], v142 offset:26624
    s_waitcnt lgkmcnt(7)
    v_mfma_f32_16x16x32_bf16 v[80:83], v[168:171], v[128:131], v[80:83]
    ds_read_b128 v[128:131], v142 offset:28672
    s_waitcnt lgkmcnt(7)
    v_mfma_f32_16x16x32_bf16 v[80:83], v[172:175], v[132:135], v[80:83]
    ds_read_b128 v[132:135], v142 offset:30720
    s_waitcnt lgkmcnt(7)
    v_mfma_f32_16x16x32_bf16 v[80:83], v[176:179], v[104:107], v[80:83]
    ds_read_b128 v[104:107], v142 offset:32768
    s_waitcnt lgkmcnt(7)
    v_mfma_f32_16x16x32_bf16 v[80:83], v[180:183], v[108:111], v[80:83]
    ds_read_b128 v[108:111], v142 offset:34816
    s_waitcnt lgkmcnt(7)
    v_mfma_f32_16x16x32_bf16 v[80:83], v[184:187], v[112:115], v[80:83]
    ds_read_b128 v[112:115], v142 offset:36864
    s_waitcnt lgkmcnt(7)
    v_mfma_f32_16x16x32_bf16 v[80:83], v[188:191], v[116:119], v[80:83]
    ds_read_b128 v[116:119], v142 offset:38912
    s_waitcnt lgkmcnt(7)
    v_mfma_f32_16x16x32_bf16 v[80:83], v[192:195], v[120:123], v[80:83]
    s_waitcnt lgkmcnt(6)
    v_mfma_f32_16x16x32_bf16 v[80:83], v[196:199], v[124:127], v[80:83]
    s_waitcnt lgkmcnt(5)
    v_mfma_f32_16x16x32_bf16 v[80:83], v[200:203], v[128:131], v[80:83]
    s_waitcnt lgkmcnt(4)
    v_mfma_f32_16x16x32_bf16 v[80:83], v[204:207], v[132:135], v[80:83]
    s_waitcnt lgkmcnt(3)
    v_mfma_f32_16x16x32_bf16 v[80:83], v[208:211], v[104:107], v[80:83]
    s_waitcnt lgkmcnt(2)
    v_mfma_f32_16x16x32_bf16 v[80:83], v[212:215], v[108:111], v[80:83]
    s_waitcnt lgkmcnt(1)
    v_mfma_f32_16x16x32_bf16 v[80:83], v[216:219], v[112:115], v[80:83]
    s_waitcnt lgkmcnt(0)
    v_mfma_f32_16x16x32_bf16 v[80:83], v[220:223], v[116:119], v[80:83]
    s_nop 7
    v_mul_f32 v84, s29, v80
    v_mul_f32 v85, s29, v81
    v_mul_f32 v86, s29, v82
    v_mul_f32 v87, s29, v83
    v_exp_f32 v84, v84
    v_exp_f32 v85, v85
    v_exp_f32 v86, v86
    v_exp_f32 v87, v87
    v_add_f32 v84, 1.0, v84
    v_add_f32 v85, 1.0, v85
    v_add_f32 v86, 1.0, v86
    v_add_f32 v87, 1.0, v87
    v_rcp_f32 v84, v84
    v_rcp_f32 v85, v85
    v_rcp_f32 v86, v86
    v_rcp_f32 v87, v87
    v_mul_f32 v84, v80, v84
    v_mul_f32 v85, v81, v85
    v_mul_f32 v86, v82, v86
    v_mul_f32 v87, v83, v87
    v_cvt_pk_bf16_f32 v88, v84, v85
    v_cvt_pk_bf16_f32 v89, v86, v87
    s_add_u32 s74, s64, 1
    s_and_b32 s74, s74, 7
    s_mul_i32 s74, s74, 98304
    s_add_u32 s74, s74, s28
    buffer_store_dwordx2 v[88:89], v1, s[4:7], s74 offen
    s_cmp_lg_u32 s63, 0
    s_cbranch_scc1 Lslow_46
Lback_47:
    v_xor_b32 v142, 40960, v142
L_SA23_next:
    s_waitcnt lgkmcnt(0)
    s_add_u32 s64, s64, 1
    s_cmp_lt_i32 s64, 64
    s_cbranch_scc1 L_SA23_loop
    s_cmp_lg_u32 s68, s87
    s_cbranch_scc1 L_end
    s_add_u32 s88, s64, 3
    s_and_b32 s88, s88, 3
    s_mul_i32 s88, s88, 475136
    s_add_u32 s88, s88, s82
    s_add_u32 s89, s88, 2560
    v_mov_b32 v80, v92
    v_mov_b32 v81, v93
    v_mov_b32 v82, v94
    v_mov_b32 v83, v95
    v_mov_b32 v84, v96
    v_mov_b32 v85, v97
    v_mov_b32 v86, v98
    v_mov_b32 v87, v99
    v_mov_b32 v88, v100
    v_mov_b32 v89, v101
Lpoll_48:
    buffer_load_dwordx4 v[104:107], v1, s[4:7], s88 offen sc1
    buffer_load_dwordx4 v[108:111], v1, s[4:7], s88 offen offset:1024 sc1
    buffer_load_dwordx2 v[112:113], v11, s[4:7], s88 offen offset:2048 sc1
    buffer_load_dwordx4 v[116:119], v1, s[4:7], s89 offen sc1
    buffer_load_dwordx4 v[120:123], v1, s[4:7], s89 offen offset:1024 sc1
    buffer_load_dwordx2 v[124:125], v11, s[4:7], s89 offen offset:2048 sc1
    s_waitcnt vmcnt(0)
    v_max3_u32 v2, v104, v105, v106
    v_max3_u32 v2, v2, v107, v108
    v_max3_u32 v2, v2, v109, v110
    v_max3_u32 v2, v2, v111, v112
    v_max3_u32 v2, v2, v113, v116
    v_max3_u32 v2, v2, v117, v118
    v_max3_u32 v2, v2, v119, v120
    v_max3_u32 v2, v2, v121, v122
    v_max3_u32 v2, v2, v123, v124
    v_max_u32 v2, v2, v125
    v_cmp_eq_u32 vcc, -1, v2
    s_cbranch_vccnz Lretry_49
Ldone_50:
    v_add_f32 v80, v80, v104
    v_add_f32 v81, v81, v105
    v_add_f32 v82, v82, v106
    v_add_f32 v83, v83, v107
    v_add_f32 v84, v84, v108
    v_add_f32 v85, v85, v109
    v_add_f32 v86, v86, v110
    v_add_f32 v87, v87, v111
    v_add_f32 v88, v88, v112
    v_add_f32 v89, v89, v113
    v_add_f32 v80, v80, v116
    v_add_f32 v81, v81, v117
    v_add_f32 v82, v82, v118
    v_add_f32 v83, v83, v119
    v_add_f32 v84, v84, v120
    v_add_f32 v85, v85, v121
    v_add_f32 v86, v86, v122
    v_add_f32 v87, v87, v123
    v_add_f32 v88, v88, v124
    v_add_f32 v89, v89, v125
    v_mov_b32 v3, 0xff800000
    v_cmp_le_i32 vcc, 0, v10
    s_nop 1
    v_cndmask_b32 v80, v3, v80, vcc
    v_cmp_le_i32 vcc, 1, v10
    s_nop 1
    v_cndmask_b32 v81, v3, v81, vcc
    v_cmp_le_i32 vcc, 2, v10
    s_nop 1
    v_cndmask_b32 v82, v3, v82, vcc
    v_cmp_le_i32 vcc, 3, v10
    s_nop 1
    v_cndmask_b32 v83, v3, v83, vcc
    v_cmp_le_i32 vcc, 16, v10
    s_nop 1
    v_cndmask_b32 v84, v3, v84, vcc
    v_cmp_le_i32 vcc, 17, v10
    s_nop 1
    v_cndmask_b32 v85, v3, v85, vcc
    v_cmp_le_i32 vcc, 18, v10
    s_nop 1
    v_cndmask_b32 v86, v3, v86, vcc
    v_cmp_le_i32 vcc, 19, v10
    s_nop 1
    v_cndmask_b32 v87, v3, v87, vcc
    v_max3_f32 v140, v80, v81, v82
    v_max3_f32 v140, v140, v83, v84
    v_max3_f32 v140, v140, v85, v86
    v_max3_f32 v140, v140, v87, v88
    v_max_f32 v140, v140, v89
    v_mov_b32 v141, v140
    s_nop 1
    v_permlane16_swap_b32 v140, v141
    v_max_f32 v140, v140, v141
    v_mov_b32 v141, v140
    s_nop 1
    v_permlane32_swap_b32 v140, v141
    v_max_f32 v140, v140, v141
    v_sub_f32 v128, v80, v140
    v_sub_f32 v129, v81, v140
    v_sub_f32 v130, v82, v140
    v_sub_f32 v131, v83, v140
    v_sub_f32 v132, v84, v140
    v_sub_f32 v133, v85, v140
    v_sub_f32 v134, v86, v140
    v_sub_f32 v135, v87, v140
    v_sub_f32 v136, v88, v140
    v_sub_f32 v137, v89, v140
    v_mul_f32 v128, s70, v128
    v_mul_f32 v129, s70, v129
    v_mul_f32 v130, s70, v130
    v_mul_f32 v131, s70, v131
    v_mul_f32 v132, s70, v132
    v_mul_f32 v133, s70, v133
    v_mul_f32 v134, s70, v134
    v_mul_f32 v135, s70, v135
    v_mul_f32 v136, s70, v136
    v_mul_f32 v137, s70, v137
    v_exp_f32 v128, v128
    v_exp_f32 v129, v129
    v_exp_f32 v130, v130
    v_exp_f32 v131, v131
    v_exp_f32 v132, v132
    v_exp_f32 v133, v133
    v_exp_f32 v134, v134
    v_exp_f32 v135, v135
    v_exp_f32 v136, v136
    v_exp_f32 v137, v137
    v_add_f32 v140, v128, v129
    v_add_f32 v140, v140, v130
    v_add_f32 v140, v140, v131
    v_add_f32 v140, v140, v132
    v_add_f32 v140, v140, v133
    v_add_f32 v140, v140, v134
    v_add_f32 v140, v140, v135
    v_add_f32 v140, v140, v136
    v_add_f32 v140, v140, v137
    v_mov_b32 v141, v140
    s_nop 1
    v_permlane16_swap_b32 v140, v141
    v_add_f32 v140, v140, v141
    v_mov_b32 v141, v140
    s_nop 1
    v_permlane32_swap_b32 v140, v141
    v_add_f32 v140, v140, v141
    v_rcp_f32 v140, v140
    s_nop 0
    v_mul_f32 v128, v128, v140
    v_mul_f32 v129, v129, v140
    v_mul_f32 v130, v130, v140
    v_mul_f32 v131, v131, v140
    v_mul_f32 v132, v132, v140
    v_mul_f32 v133, v133, v140
    v_mul_f32 v134, v134, v140
    v_mul_f32 v135, v135, v140
    v_mul_f32 v136, v136, v140
    v_mul_f32 v137, v137, v140
    v_cvt_pk_bf16_f32 v80, v128, v129
    v_cvt_pk_bf16_f32 v81, v130, v131
    v_cvt_pk_bf16_f32 v82, v132, v133
    v_cvt_pk_bf16_f32 v83, v134, v135
    v_cvt_pk_bf16_f32 v84, v136, v137
    s_add_u32 s74, s64, 3
    s_and_b32 s74, s74, 3
    s_mul_i32 s74, s74, 81920
    s_add_u32 s74, s74, s86
    buffer_store_dwordx4 v[80:83], v1, s[4:7], s74 offen
    buffer_store_dword v84, v12, s[4:7], s74 offen offset:1024
    s_cmp_lg_u32 s63, 0
    s_cbranch_scc1 Lslow_51
Lback_52:
    s_and_b32 s72, s67, 3
    s_lshl_b32 s72, s72, 1
    s_add_u32 s72, s72, s87
    s_lshl_b32 s72, s72, 2
    s_lshl_b32 s73, s61, 7
    s_add_u32 s72, s72, s73
    s_add_u32 s72, s72, 5541888
    v_mov_b32 v2, 1
    s_mov_b64 exec, 1
    s_waitcnt vmcnt(0)
    buffer_store_dword v2, off, s[4:7], s72
    s_cmp_lg_u32 s63, 0
    s_cbranch_scc1 Lslow_53
Lback_54:
    s_endpgm
L_ZM:
    s_mov_b32 s20, s40
    s_and_b32 s21, s41, 0xffff
    s_mov_b32 s22, 7864320
    s_mov_b32 s23, 0x00020000
    s_mov_b32 s24, s42
    s_and_b32 s25, s43, 0xffff
    s_mov_b32 s26, 7864320
    s_mov_b32 s27, 0x00020000
    s_lshl_b32 s67, s61, 2
    s_add_u32 s67, s67, s66
    s_mul_i32 s91, s66, 24576
    s_add_u32 s91, s91, 40960
    v_add_u32 v7, 0, v0
    v_mul_u32_u24 v1, 2731, v7
    v_lshrrev_b32 v1, 16, v1
    v_mul_u32_u24 v248, 24, v1
    v_sub_u32 v7, v7, v248
    v_lshrrev_b32 v248, 1, v1
    v_xor_b32 v7, v7, v248
    v_and_b32 v248, 12, v1
    v_add_u32 v1, v1, v248
    v_mul_u32_u24 v1, 12288, v1
    v_lshl_add_u32 v1, v7, 4, v1
    v_add_u32 v7, 64, v0
    v_mul_u32_u24 v2, 2731, v7
    v_lshrrev_b32 v2, 16, v2
    v_mul_u32_u24 v248, 24, v2
    v_sub_u32 v7, v7, v248
    v_lshrrev_b32 v248, 1, v2
    v_xor_b32 v7, v7, v248
    v_and_b32 v248, 12, v2
    v_add_u32 v2, v2, v248
    v_mul_u32_u24 v2, 12288, v2
    v_lshl_add_u32 v2, v7, 4, v2
    v_add_u32 v7, 128, v0
    v_mul_u32_u24 v3, 2731, v7
    v_lshrrev_b32 v3, 16, v3
    v_mul_u32_u24 v248, 24, v3
    v_sub_u32 v7, v7, v248
    v_lshrrev_b32 v248, 1, v3
    v_xor_b32 v7, v7, v248
    v_and_b32 v248, 12, v3
    v_add_u32 v3, v3, v248
    v_mul_u32_u24 v3, 12288, v3
    v_lshl_add_u32 v3, v7, 4, v3
    v_add_u32 v7, 192, v0
    v_mul_u32_u24 v4, 2731, v7
    v_lshrrev_b32 v4, 16, v4
    v_mul_u32_u24 v248, 24, v4
    v_sub_u32 v7, v7, v248
    v_lshrrev_b32 v248, 1, v4
    v_xor_b32 v7, v7, v248
    v_and_b32 v248, 12, v4
    v_add_u32 v4, v4, v248
    v_mul_u32_u24 v4, 12288, v4
    v_lshl_add_u32 v4, v7, 4, v4
    v_add_u32 v7, 256, v0
    v_mul_u32_u24 v5, 2731, v7
    v_lshrrev_b32 v5, 16, v5
    v_mul_u32_u24 v248, 24, v5
    v_sub_u32 v7, v7, v248
    v_lshrrev_b32 v248, 1, v5
    v_xor_b32 v7, v7, v248
    v_and_b32 v248, 12, v5
    v_add_u32 v5, v5, v248
    v_mul_u32_u24 v5, 12288, v5
    v_lshl_add_u32 v5, v7, 4, v5
    v_add_u32 v7, 320, v0
    v_mul_u32_u24 v6, 2731, v7
    v_lshrrev_b32 v6, 16, v6
    v_mul_u32_u24 v248, 24, v6
    v_sub_u32 v7, v7, v248
    v_lshrrev_b32 v248, 1, v6
    v_xor_b32 v7, v7, v248
    v_and_b32 v248, 12, v6
    v_add_u32 v6, v6, v248
    v_mul_u32_u24 v6, 12288, v6
    v_lshl_add_u32 v6, v7, 4, v6
    v_and_b32 v7, 15, v0
    v_lshrrev_b32 v248, 1, v7
    v_lshrrev_b32 v198, 4, v0
    v_xor_b32 v198, v198, v248
    v_xor_b32 v249, 4, v198
    v_mul_u32_u24 v7, 384, v7
    v_add_u32 v7, s91, v7
    v_lshl_add_u32 v198, v198, 4, v7
    v_lshl_add_u32 v249, v249, 4, v7
    s_mul_i32 s81, s67, 384
    v_and_b32 v7, 1, v0
    v_bfe_u32 v199, v0, 1, 2
    v_lshl_add_u32 v7, v199, 2, v7
    v_bfe_u32 v199, v0, 3, 1
    v_lshl_add_u32 v7, v199, 1, v7
    v_lshrrev_b32 v199, 3, v7
    v_lshrrev_b32 v248, 4, v0
    v_cmp_eq_u32 vcc, v199, v248
    v_and_b32 v199, 1, v7
    v_lshlrev_b32 v199, 4, v199
    v_mov_b32 v248, 0x3f80
    v_lshlrev_b32 v199, v199, v248
    v_cndmask_b32 v199, 0, v199, vcc
    v_bfe_u32 v248, v7, 1, 2
    v_cmp_eq_u32 vcc, 0, v248
    s_nop 1
    v_cndmask_b32 v160, 0, v199, vcc
    v_cmp_eq_u32 vcc, 1, v248
    s_nop 1
    v_cndmask_b32 v161, 0, v199, vcc
    v_cmp_eq_u32 vcc, 2, v248
    s_nop 1
    v_cndmask_b32 v162, 0, v199, vcc
    v_cmp_eq_u32 vcc, 3, v248
    s_nop 1
    v_cndmask_b32 v163, 0, v199, vcc
    v_and_b32 v7, 1, v0
    v_bfe_u32 v199, v0, 1, 2
    v_lshl_add_u32 v7, v199, 2, v7
    v_bfe_u32 v199, v0, 3, 1
    v_lshl_add_u32 v7, v199, 1, v7
    v_add_u32 v7, 16, v7
    v_lshrrev_b32 v199, 3, v7
    v_lshrrev_b32 v248, 4, v0
    v_cmp_eq_u32 vcc, v199, v248
    v_and_b32 v199, 1, v7
    v_lshlrev_b32 v199, 4, v199
    v_mov_b32 v248, 0x3f80
    v_lshlrev_b32 v199, v199, v248
    v_cndmask_b32 v199, 0, v199, vcc
    v_bfe_u32 v248, v7, 1, 2
    v_cmp_eq_u32 vcc, 0, v248
    s_nop 1
    v_cndmask_b32 v164, 0, v199, vcc
    v_cmp_eq_u32 vcc, 1, v248
    s_nop 1
    v_cndmask_b32 v165, 0, v199, vcc
    v_cmp_eq_u32 vcc, 2, v248
    s_nop 1
    v_cndmask_b32 v166, 0, v199, vcc
    v_cmp_eq_u32 vcc, 3, v248
    s_nop 1
    v_cndmask_b32 v167, 0, v199, vcc
    v_lshrrev_b32 v7, 4, v0
    v_lshlrev_b32 v7, 3, v7
    v_bfe_u32 v199, v0, 2, 2
    v_add_u32 v7, v7, v199
    v_mul_u32_u24 v7, 1280, v7
    v_and_b32 v199, 3, v0
    v_lshl_add_u32 v7, v199, 4, v7
    s_mul_i32 s80, s67, 245760
    s_lshl_b32 s73, s62, 6
    s_add_u32 s80, s80, s73
    v_mov_b32 v199, 163600
    s_mov_b32 s72, 4
Lflag_55:
    ds_read_b32 v248, v199
    s_waitcnt lgkmcnt(0)
    v_cmp_gt_i32 vcc, s72, v248
    s_cbranch_vccz Lflagd_56
    s_sleep 1
    s_branch Lflag_55
Lflagd_56:
    v_and_b32 v199, 15, v0
    v_lshlrev_b32 v199, 6, v199
    v_and_b32 v248, 0x30, v0
    v_add3_u32 v199, v199, v248, s91
    s_add_u32 m0, s91, 0
    s_add_u32 s72, s80, 0
    buffer_load_dwordx4 v7, s[24:27], s72 offen lds
    s_add_u32 m0, s91, 1024
    s_add_u32 s72, s80, 5120
    buffer_load_dwordx4 v7, s[24:27], s72 offen lds
    s_add_u32 m0, s91, 2048
    s_add_u32 s72, s80, 40960
    buffer_load_dwordx4 v7, s[24:27], s72 offen lds
    s_add_u32 m0, s91, 3072
    s_add_u32 s72, s80, 46080
    buffer_load_dwordx4 v7, s[24:27], s72 offen lds
    s_add_u32 m0, s91, 4096
    s_add_u32 s72, s80, 81920
    buffer_load_dwordx4 v7, s[24:27], s72 offen lds
    s_add_u32 m0, s91, 5120
    s_add_u32 s72, s80, 87040
    buffer_load_dwordx4 v7, s[24:27], s72 offen lds
    s_add_u32 m0, s91, 6144
    s_add_u32 s72, s80, 122880
    buffer_load_dwordx4 v7, s[24:27], s72 offen lds
    s_add_u32 m0, s91, 7168
    s_add_u32 s72, s80, 128000
    buffer_load_dwordx4 v7, s[24:27], s72 offen lds
    s_add_u32 m0, s91, 8192
    s_add_u32 s72, s80, 163840
    buffer_load_dwordx4 v7, s[24:27], s72 offen lds
    s_add_u32 m0, s91, 9216
    s_add_u32 s72, s80, 168960
    buffer_load_dwordx4 v7, s[24:27], s72 offen lds
    s_add_u32 m0, s91, 10240
    s_add_u32 s72, s80, 204800
    buffer_load_dwordx4 v7, s[24:27], s72 offen lds
    s_add_u32 m0, s91, 11264
    s_add_u32 s72, s80, 209920
    buffer_load_dwordx4 v7, s[24:27], s72 offen lds
    s_add_u32 s72, s81, 0
    s_add_u32 m0, s91, 12288
    s_nop 0
    buffer_load_dwordx4 v1, s[20:23], s72 offen lds
    s_add_u32 m0, s91, 13312
    s_nop 0
    buffer_load_dwordx4 v2, s[20:23], s72 offen lds
    s_add_u32 m0, s91, 14336
    s_nop 0
    buffer_load_dwordx4 v3, s[20:23], s72 offen lds
    s_add_u32 m0, s91, 15360
    s_nop 0
    buffer_load_dwordx4 v4, s[20:23], s72 offen lds
    s_add_u32 m0, s91, 16384
    s_nop 0
    buffer_load_dwordx4 v5, s[20:23], s72 offen lds
    s_add_u32 m0, s91, 17408
    s_nop 0
    buffer_load_dwordx4 v6, s[20:23], s72 offen lds
    s_add_u32 s72, s81, 49152
    s_add_u32 m0, s91, 18432
    s_nop 0
    buffer_load_dwordx4 v1, s[20:23], s72 offen lds
    s_add_u32 m0, s91, 19456
    s_nop 0
    buffer_load_dwordx4 v2, s[20:23], s72 offen lds
    s_add_u32 m0, s91, 20480
    s_nop 0
    buffer_load_dwordx4 v3, s[20:23], s72 offen lds
    s_add_u32 m0, s91, 21504
    s_nop 0
    buffer_load_dwordx4 v4, s[20:23], s72 offen lds
    s_add_u32 m0, s91, 22528
    s_nop 0
    buffer_load_dwordx4 v5, s[20:23], s72 offen lds
    s_add_u32 m0, s91, 23552
    s_nop 0
    buffer_load_dwordx4 v6, s[20:23], s72 offen lds
    s_waitcnt vmcnt(23)
    ds_read_b128 v[8:11], v199 offset:0
    s_waitcnt vmcnt(22)
    ds_read_b128 v[12:15], v199 offset:1024
    s_waitcnt lgkmcnt(1)
    v_mfma_f32_16x16x32_bf16 v[56:59], v[8:11], v[160:163], 0
    v_mfma_f32_16x16x32_bf16 v[60:63], v[8:11], v[164:167], 0
    s_waitcnt vmcnt(21)
    ds_read_b128 v[16:19], v199 offset:2048
    s_waitcnt lgkmcnt(1)
    v_mfma_f32_16x16x32_bf16 v[64:67], v[12:15], v[160:163], 0
    v_mfma_f32_16x16x32_bf16 v[68:71], v[12:15], v[164:167], 0
    s_nop 1
    v_cvt_pk_bf16_f32 v200, v56, v57
    v_cvt_pk_bf16_f32 v201, v58, v59
    v_cvt_pk_bf16_f32 v204, v60, v61
    v_cvt_pk_bf16_f32 v205, v62, v63
    s_waitcnt vmcnt(20)
    ds_read_b128 v[8:11], v199 offset:3072
    s_waitcnt lgkmcnt(1)
    v_mfma_f32_16x16x32_bf16 v[56:59], v[16:19], v[160:163], 0
    v_mfma_f32_16x16x32_bf16 v[60:63], v[16:19], v[164:167], 0
    v_cvt_pk_bf16_f32 v202, v64, v65
    v_cvt_pk_bf16_f32 v203, v66, v67
    v_cvt_pk_bf16_f32 v206, v68, v69
    v_cvt_pk_bf16_f32 v207, v70, v71
    s_waitcnt vmcnt(19)
    ds_read_b128 v[12:15], v199 offset:4096
    s_waitcnt lgkmcnt(1)
    v_mfma_f32_16x16x32_bf16 v[64:67], v[8:11], v[160:163], 0
    v_mfma_f32_16x16x32_bf16 v[68:71], v[8:11], v[164:167], 0
    v_cvt_pk_bf16_f32 v208, v56, v57
    v_cvt_pk_bf16_f32 v209, v58, v59
    v_cvt_pk_bf16_f32 v212, v60, v61
    v_cvt_pk_bf16_f32 v213, v62, v63
    s_waitcnt vmcnt(18)
    ds_read_b128 v[16:19], v199 offset:5120
    s_waitcnt lgkmcnt(1)
    v_mfma_f32_16x16x32_bf16 v[56:59], v[12:15], v[160:163], 0
    v_mfma_f32_16x16x32_bf16 v[60:63], v[12:15], v[164:167], 0
    v_cvt_pk_bf16_f32 v210, v64, v65
    v_cvt_pk_bf16_f32 v211, v66, v67
    v_cvt_pk_bf16_f32 v214, v68, v69
    v_cvt_pk_bf16_f32 v215, v70, v71
    s_waitcnt vmcnt(17)
    ds_read_b128 v[8:11], v199 offset:6144
    s_waitcnt lgkmcnt(1)
    v_mfma_f32_16x16x32_bf16 v[64:67], v[16:19], v[160:163], 0
    v_mfma_f32_16x16x32_bf16 v[68:71], v[16:19], v[164:167], 0
    v_cvt_pk_bf16_f32 v216, v56, v57
    v_cvt_pk_bf16_f32 v217, v58, v59
    v_cvt_pk_bf16_f32 v220, v60, v61
    v_cvt_pk_bf16_f32 v221, v62, v63
    s_waitcnt vmcnt(16)
    ds_read_b128 v[12:15], v199 offset:7168
    s_waitcnt lgkmcnt(1)
    v_mfma_f32_16x16x32_bf16 v[56:59], v[8:11], v[160:163], 0
    v_mfma_f32_16x16x32_bf16 v[60:63], v[8:11], v[164:167], 0
    v_cvt_pk_bf16_f32 v218, v64, v65
    v_cvt_pk_bf16_f32 v219, v66, v67
    v_cvt_pk_bf16_f32 v222, v68, v69
    v_cvt_pk_bf16_f32 v223, v70, v71
    s_waitcnt vmcnt(15)
    ds_read_b128 v[16:19], v199 offset:8192
    s_waitcnt lgkmcnt(1)
    v_mfma_f32_16x16x32_bf16 v[64:67], v[12:15], v[160:163], 0
    v_mfma_f32_16x16x32_bf16 v[68:71], v[12:15], v[164:167], 0
    v_cvt_pk_bf16_f32 v224, v56, v57
    v_cvt_pk_bf16_f32 v225, v58, v59
    v_cvt_pk_bf16_f32 v228, v60, v61
    v_cvt_pk_bf16_f32 v229, v62, v63
    s_waitcnt vmcnt(14)
    ds_read_b128 v[8:11], v199 offset:9216
    s_waitcnt lgkmcnt(1)
    v_mfma_f32_16x16x32_bf16 v[56:59], v[16:19], v[160:163], 0
    v_mfma_f32_16x16x32_bf16 v[60:63], v[16:19], v[164:167], 0
    v_cvt_pk_bf16_f32 v226, v64, v65
    v_cvt_pk_bf16_f32 v227, v66, v67
    v_cvt_pk_bf16_f32 v230, v68, v69
    v_cvt_pk_bf16_f32 v231, v70, v71
    s_waitcnt vmcnt(13)
    ds_read_b128 v[12:15], v199 offset:10240
    s_waitcnt lgkmcnt(1)
    v_mfma_f32_16x16x32_bf16 v[64:67], v[8:11], v[160:163], 0
    v_mfma_f32_16x16x32_bf16 v[68:71], v[8:11], v[164:167], 0
    v_cvt_pk_bf16_f32 v232, v56, v57
    v_cvt_pk_bf16_f32 v233, v58, v59
    v_cvt_pk_bf16_f32 v236, v60, v61
    v_cvt_pk_bf16_f32 v237, v62, v63
    s_waitcnt vmcnt(12)
    ds_read_b128 v[16:19], v199 offset:11264
    s_waitcnt lgkmcnt(1)
    v_mfma_f32_16x16x32_bf16 v[56:59], v[12:15], v[160:163], 0
    v_mfma_f32_16x16x32_bf16 v[60:63], v[12:15], v[164:167], 0
    v_cvt_pk_bf16_f32 v234, v64, v65
    v_cvt_pk_bf16_f32 v235, v66, v67
    v_cvt_pk_bf16_f32 v238, v68, v69
    v_cvt_pk_bf16_f32 v239, v70, v71
    s_waitcnt lgkmcnt(0)
    v_mfma_f32_16x16x32_bf16 v[64:67], v[16:19], v[160:163], 0
    v_mfma_f32_16x16x32_bf16 v[68:71], v[16:19], v[164:167], 0
    v_cvt_pk_bf16_f32 v240, v56, v57
    v_cvt_pk_bf16_f32 v241, v58, v59
    v_cvt_pk_bf16_f32 v244, v60, v61
    v_cvt_pk_bf16_f32 v245, v62, v63
    s_nop 2
    v_cvt_pk_bf16_f32 v242, v64, v65
    v_cvt_pk_bf16_f32 v243, v66, v67
    v_cvt_pk_bf16_f32 v246, v68, v69
    v_cvt_pk_bf16_f32 v247, v70, v71
    s_add_u32 s72, s81, 393216
    s_add_u32 m0, s91, 0
    s_nop 0
    buffer_load_dwordx4 v1, s[20:23], s72 offen lds
    s_add_u32 m0, s91, 1024
    s_nop 0
    buffer_load_dwordx4 v2, s[20:23], s72 offen lds
    s_add_u32 m0, s91, 2048
    s_nop 0
    buffer_load_dwordx4 v3, s[20:23], s72 offen lds
    s_add_u32 m0, s91, 3072
    s_nop 0
    buffer_load_dwordx4 v4, s[20:23], s72 offen lds
    s_add_u32 m0, s91, 4096
    s_nop 0
    buffer_load_dwordx4 v5, s[20:23], s72 offen lds
    s_add_u32 m0, s91, 5120
    s_nop 0
    buffer_load_dwordx4 v6, s[20:23], s72 offen lds
    s_waitcnt vmcnt(12)
    ds_read_b128 v[184:187], v198 offset:12288
    ds_read_b128 v[188:191], v249 offset:12288
    s_add_u32 s72, s81, 442368
    s_add_u32 m0, s91, 6144
    s_nop 0
    buffer_load_dwordx4 v1, s[20:23], s72 offen lds
    s_waitcnt lgkmcnt(1)
    v_mfma_f32_16x16x32_bf16 v[168:171], v[184:187], v[200:203], 0
    v_mfma_f32_16x16x32_bf16 v[172:175], v[184:187], v[204:207], 0
    ds_read_b128 v[192:195], v198 offset:12416
    s_add_u32 m0, s91, 7168
    s_nop 0
    buffer_load_dwordx4 v2, s[20:23], s72 offen lds
    s_waitcnt lgkmcnt(1)
    v_mfma_f32_16x16x32_bf16 v[168:171], v[188:191], v[208:211], v[168:171]
    v_mfma_f32_16x16x32_bf16 v[172:175], v[188:191], v[212:215], v[172:175]
    ds_read_b128 v[184:187], v249 offset:12416
    s_add_u32 m0, s91, 8192
    s_nop 0
    buffer_load_dwordx4 v3, s[20:23], s72 offen lds
    s_waitcnt lgkmcnt(1)
    v_mfma_f32_16x16x32_bf16 v[168:171], v[192:195], v[216:219], v[168:171]
    v_mfma_f32_16x16x32_bf16 v[172:175], v[192:195], v[220:223], v[172:175]
    ds_read_b128 v[188:191], v198 offset:12544
    s_add_u32 m0, s91, 9216
    s_nop 0
    buffer_load_dwordx4 v4, s[20:23], s72 offen lds
    s_waitcnt lgkmcnt(1)
    v_mfma_f32_16x16x32_bf16 v[168:171], v[184:187], v[224:227], v[168:171]
    v_mfma_f32_16x16x32_bf16 v[172:175], v[184:187], v[228:231], v[172:175]
    ds_read_b128 v[192:195], v249 offset:12544
    s_add_u32 m0, s91, 10240
    s_nop 0
    buffer_load_dwordx4 v5, s[20:23], s72 offen lds
    s_waitcnt lgkmcnt(1)
    v_mfma_f32_16x16x32_bf16 v[168:171], v[188:191], v[232:235], v[168:171]
    v_mfma_f32_16x16x32_bf16 v[172:175], v[188:191], v[236:239], v[172:175]
    s_waitcnt vmcnt(11)
    ds_read_b128 v[184:187], v198 offset:18432
    s_add_u32 m0, s91, 11264
    s_nop 0
    buffer_load_dwordx4 v6, s[20:23], s72 offen lds
    s_waitcnt lgkmcnt(1)
    v_mfma_f32_16x16x32_bf16 v[168:171], v[192:195], v[240:243], v[168:171]
    v_mfma_f32_16x16x32_bf16 v[172:175], v[192:195], v[244:247], v[172:175]
    ds_read_b128 v[188:191], v249 offset:18432
    s_add_u32 s72, s81, 786432
    s_add_u32 m0, s91, 12288
    s_nop 0
    buffer_load_dwordx4 v1, s[20:23], s72 offen lds
    s_waitcnt lgkmcnt(1)
    v_mfma_f32_16x16x32_bf16 v[176:179], v[184:187], v[200:203], 0
    v_mfma_f32_16x16x32_bf16 v[180:183], v[184:187], v[204:207], 0
    ds_read_b128 v[192:195], v198 offset:18560
    s_add_u32 m0, s91, 13312
    s_nop 0
    buffer_load_dwordx4 v2, s[20:23], s72 offen lds
    s_waitcnt lgkmcnt(1)
    v_mfma_f32_16x16x32_bf16 v[176:179], v[188:191], v[208:211], v[176:179]
    v_mfma_f32_16x16x32_bf16 v[180:183], v[188:191], v[212:215], v[180:183]
    ds_read_b128 v[184:187], v249 offset:18560
    s_add_u32 m0, s91, 14336
    s_nop 0
    buffer_load_dwordx4 v3, s[20:23], s72 offen lds
    s_waitcnt lgkmcnt(1)
    v_mfma_f32_16x16x32_bf16 v[176:179], v[192:195], v[216:219], v[176:179]
    v_mfma_f32_16x16x32_bf16 v[180:183], v[192:195], v[220:223], v[180:183]
    ds_read_b128 v[188:191], v198 offset:18688
    s_add_u32 m0, s91, 15360
    s_nop 0
    buffer_load_dwordx4 v4, s[20:23], s72 offen lds
    s_waitcnt lgkmcnt(1)
    v_mfma_f32_16x16x32_bf16 v[176:179], v[184:187], v[224:227], v[176:179]
    v_mfma_f32_16x16x32_bf16 v[180:183], v[184:187], v[228:231], v[180:183]
    ds_read_b128 v[192:195], v249 offset:18688
    v_cvt_pk_bf16_f32 v8, v168, v169
    v_cvt_pk_bf16_f32 v9, v170, v171
    v_cvt_pk_bf16_f32 v88, v172, v173
    v_cvt_pk_bf16_f32 v89, v174, v175
    s_add_u32 m0, s91, 16384
    s_nop 0
    buffer_load_dwordx4 v5, s[20:23], s72 offen lds
    s_waitcnt lgkmcnt(1)
    v_mfma_f32_16x16x32_bf16 v[176:179], v[188:191], v[232:235], v[176:179]
    v_mfma_f32_16x16x32_bf16 v[180:183], v[188:191], v[236:239], v[180:183]
    s_waitcnt vmcnt(11)
    ds_read_b128 v[184:187], v198 offset:0
    s_add_u32 m0, s91, 17408
    s_nop 0
    buffer_load_dwordx4 v6, s[20:23], s72 offen lds
    s_waitcnt lgkmcnt(1)
    v_mfma_f32_16x16x32_bf16 v[176:179], v[192:195], v[240:243], v[176:179]
    v_mfma_f32_16x16x32_bf16 v[180:183], v[192:195], v[244:247], v[180:183]
    ds_read_b128 v[188:191], v249 offset:0
    s_add_u32 s72, s81, 835584
    s_add_u32 m0, s91, 18432
    s_nop 0
    buffer_load_dwordx4 v1, s[20:23], s72 offen lds
    s_waitcnt lgkmcnt(1)
    v_mfma_f32_16x16x32_bf16 v[168:171], v[184:187], v[200:203], 0
    v_mfma_f32_16x16x32_bf16 v[172:175], v[184:187], v[204:207], 0
    ds_read_b128 v[192:195], v198 offset:128
    s_add_u32 m0, s91, 19456
    s_nop 0
    buffer_load_dwordx4 v2, s[20:23], s72 offen lds
    s_waitcnt lgkmcnt(1)
    v_mfma_f32_16x16x32_bf16 v[168:171], v[188:191], v[208:211], v[168:171]
    v_mfma_f32_16x16x32_bf16 v[172:175], v[188:191], v[212:215], v[172:175]
    ds_read_b128 v[184:187], v249 offset:128
    s_add_u32 m0, s91, 20480
    s_nop 0
    buffer_load_dwordx4 v3, s[20:23], s72 offen lds
    s_waitcnt lgkmcnt(1)
    v_mfma_f32_16x16x32_bf16 v[168:171], v[192:195], v[216:219], v[168:171]
    v_mfma_f32_16x16x32_bf16 v[172:175], v[192:195], v[220:223], v[172:175]
    ds_read_b128 v[188:191], v198 offset:256
    s_add_u32 m0, s91, 21504
    s_nop 0
    buffer_load_dwordx4 v4, s[20:23], s72 offen lds
    s_waitcnt lgkmcnt(1)
    v_mfma_f32_16x16x32_bf16 v[168:171], v[184:187], v[224:227], v[168:171]
    v_mfma_f32_16x16x32_bf16 v[172:175], v[184:187], v[228:231], v[172:175]
    ds_read_b128 v[192:195], v249 offset:256
    v_cvt_pk_bf16_f32 v10, v176, v177
    v_cvt_pk_bf16_f32 v11, v178, v179
    v_cvt_pk_bf16_f32 v90, v180, v181
    v_cvt_pk_bf16_f32 v91, v182, v183
    s_add_u32 m0, s91, 22528
    s_nop 0
    buffer_load_dwordx4 v5, s[20:23], s72 offen lds
    s_waitcnt lgkmcnt(1)
    v_mfma_f32_16x16x32_bf16 v[168:171], v[188:191], v[232:235], v[168:171]
    v_mfma_f32_16x16x32_bf16 v[172:175], v[188:191], v[236:239], v[172:175]
    s_waitcnt vmcnt(11)
    ds_read_b128 v[184:187], v198 offset:6144
    s_add_u32 m0, s91, 23552
    s_nop 0
    buffer_load_dwordx4 v6, s[20:23], s72 offen lds
    s_waitcnt lgkmcnt(1)
    v_mfma_f32_16x16x32_bf16 v[168:171], v[192:195], v[240:243], v[168:171]
    v_mfma_f32_16x16x32_bf16 v[172:175], v[192:195], v[244:247], v[172:175]
    ds_read_b128 v[188:191], v249 offset:6144
    s_add_u32 s72, s81, 1179648
    s_add_u32 m0, s91, 0
    s_nop 0
    buffer_load_dwordx4 v1, s[20:23], s72 offen lds
    s_waitcnt lgkmcnt(1)
    v_mfma_f32_16x16x32_bf16 v[176:179], v[184:187], v[200:203], 0
    v_mfma_f32_16x16x32_bf16 v[180:183], v[184:187], v[204:207], 0
    ds_read_b128 v[192:195], v198 offset:6272
    s_add_u32 m0, s91, 1024
    s_nop 0
    buffer_load_dwordx4 v2, s[20:23], s72 offen lds
    s_waitcnt lgkmcnt(1)
    v_mfma_f32_16x16x32_bf16 v[176:179], v[188:191], v[208:211], v[176:179]
    v_mfma_f32_16x16x32_bf16 v[180:183], v[188:191], v[212:215], v[180:183]
    ds_read_b128 v[184:187], v249 offset:6272
    s_add_u32 m0, s91, 2048
    s_nop 0
    buffer_load_dwordx4 v3, s[20:23], s72 offen lds
    s_waitcnt lgkmcnt(1)
    v_mfma_f32_16x16x32_bf16 v[176:179], v[192:195], v[216:219], v[176:179]
    v_mfma_f32_16x16x32_bf16 v[180:183], v[192:195], v[220:223], v[180:183]
    ds_read_b128 v[188:191], v198 offset:6400
    s_add_u32 m0, s91, 3072
    s_nop 0
    buffer_load_dwordx4 v4, s[20:23], s72 offen lds
    s_waitcnt lgkmcnt(1)
    v_mfma_f32_16x16x32_bf16 v[176:179], v[184:187], v[224:227], v[176:179]
    v_mfma_f32_16x16x32_bf16 v[180:183], v[184:187], v[228:231], v[180:183]
    ds_read_b128 v[192:195], v249 offset:6400
    v_cvt_pk_bf16_f32 v12, v168, v169
    v_cvt_pk_bf16_f32 v13, v170, v171
    v_cvt_pk_bf16_f32 v92, v172, v173
    v_cvt_pk_bf16_f32 v93, v174, v175
    s_add_u32 m0, s91, 4096
    s_nop 0
    buffer_load_dwordx4 v5, s[20:23], s72 offen lds
    s_waitcnt lgkmcnt(1)
    v_mfma_f32_16x16x32_bf16 v[176:179], v[188:191], v[232:235], v[176:179]
    v_mfma_f32_16x16x32_bf16 v[180:183], v[188:191], v[236:239], v[180:183]
    s_waitcnt vmcnt(11)
    ds_read_b128 v[184:187], v198 offset:12288
    s_add_u32 m0, s91, 5120
    s_nop 0
    buffer_load_dwordx4 v6, s[20:23], s72 offen lds
    s_waitcnt lgkmcnt(1)
    v_mfma_f32_16x16x32_bf16 v[176:179], v[192:195], v[240:243], v[176:179]
    v_mfma_f32_16x16x32_bf16 v[180:183], v[192:195], v[244:247], v[180:183]
    ds_read_b128 v[188:191], v249 offset:12288
    s_add_u32 s72, s81, 1228800
    s_add_u32 m0, s91, 6144
    s_nop 0
    buffer_load_dwordx4 v1, s[20:23], s72 offen lds
    s_waitcnt lgkmcnt(1)
    v_mfma_f32_16x16x32_bf16 v[168:171], v[184:187], v[200:203], 0
    v_mfma_f32_16x16x32_bf16 v[172:175], v[184:187], v[204:207], 0
    ds_read_b128 v[192:195], v198 offset:12416
    s_add_u32 m0, s91, 7168
    s_nop 0
    buffer_load_dwordx4 v2, s[20:23], s72 offen lds
    s_waitcnt lgkmcnt(1)
    v_mfma_f32_16x16x32_bf16 v[168:171], v[188:191], v[208:211], v[168:171]
    v_mfma_f32_16x16x32_bf16 v[172:175], v[188:191], v[212:215], v[172:175]
    ds_read_b128 v[184:187], v249 offset:12416
    s_add_u32 m0, s91, 8192
    s_nop 0
    buffer_load_dwordx4 v3, s[20:23], s72 offen lds
    s_waitcnt lgkmcnt(1)
    v_mfma_f32_16x16x32_bf16 v[168:171], v[192:195], v[216:219], v[168:171]
    v_mfma_f32_16x16x32_bf16 v[172:175], v[192:195], v[220:223], v[172:175]
    ds_read_b128 v[188:191], v198 offset:12544
    s_add_u32 m0, s91, 9216
    s_nop 0
    buffer_load_dwordx4 v4, s[20:23], s72 offen lds
    s_waitcnt lgkmcnt(1)
    v_mfma_f32_16x16x32_bf16 v[168:171], v[184:187], v[224:227], v[168:171]
    v_mfma_f32_16x16x32_bf16 v[172:175], v[184:187], v[228:231], v[172:175]
    ds_read_b128 v[192:195], v249 offset:12544
    v_cvt_pk_bf16_f32 v14, v176, v177
    v_cvt_pk_bf16_f32 v15, v178, v179
    v_cvt_pk_bf16_f32 v94, v180, v181
    v_cvt_pk_bf16_f32 v95, v182, v183
    s_add_u32 m0, s91, 10240
    s_nop 0
    buffer_load_dwordx4 v5, s[20:23], s72 offen lds
    s_waitcnt lgkmcnt(1)
    v_mfma_f32_16x16x32_bf16 v[168:171], v[188:191], v[232:235], v[168:171]
    v_mfma_f32_16x16x32_bf16 v[172:175], v[188:191], v[236:239], v[172:175]
    s_waitcnt vmcnt(11)
    ds_read_b128 v[184:187], v198 offset:18432
    s_add_u32 m0, s91, 11264
    s_nop 0
    buffer_load_dwordx4 v6, s[20:23], s72 offen lds
    s_waitcnt lgkmcnt(1)
    v_mfma_f32_16x16x32_bf16 v[168:171], v[192:195], v[240:243], v[168:171]
    v_mfma_f32_16x16x32_bf16 v[172:175], v[192:195], v[244:247], v[172:175]
    ds_read_b128 v[188:191], v249 offset:18432
    s_add_u32 s72, s81, 1572864
    s_add_u32 m0, s91, 12288
    s_nop 0
    buffer_load_dwordx4 v1, s[20:23], s72 offen lds
    s_waitcnt lgkmcnt(1)
    v_mfma_f32_16x16x32_bf16 v[176:179], v[184:187], v[200:203], 0
    v_mfma_f32_16x16x32_bf16 v[180:183], v[184:187], v[204:207], 0
    ds_read_b128 v[192:195], v198 offset:18560
    s_add_u32 m0, s91, 13312
    s_nop 0
    buffer_load_dwordx4 v2, s[20:23], s72 offen lds
    s_waitcnt lgkmcnt(1)
    v_mfma_f32_16x16x32_bf16 v[176:179], v[188:191], v[208:211], v[176:179]
    v_mfma_f32_16x16x32_bf16 v[180:183], v[188:191], v[212:215], v[180:183]
    ds_read_b128 v[184:187], v249 offset:18560
    s_add_u32 m0, s91, 14336
    s_nop 0
    buffer_load_dwordx4 v3, s[20:23], s72 offen lds
    s_waitcnt lgkmcnt(1)
    v_mfma_f32_16x16x32_bf16 v[176:179], v[192:195], v[216:219], v[176:179]
    v_mfma_f32_16x16x32_bf16 v[180:183], v[192:195], v[220:223], v[180:183]
    ds_read_b128 v[188:191], v198 offset:18688
    s_add_u32 m0, s91, 15360
    s_nop 0
    buffer_load_dwordx4 v4, s[20:23], s72 offen lds
    s_waitcnt lgkmcnt(1)
    v_mfma_f32_16x16x32_bf16 v[176:179], v[184:187], v[224:227], v[176:179]
    v_mfma_f32_16x16x32_bf16 v[180:183], v[184:187], v[228:231], v[180:183]
    ds_read_b128 v[192:195], v249 offset:18688
    v_cvt_pk_bf16_f32 v16, v168, v169
    v_cvt_pk_bf16_f32 v17, v170, v171
    v_cvt_pk_bf16_f32 v96, v172, v173
    v_cvt_pk_bf16_f32 v97, v174, v175
    s_add_u32 m0, s91, 16384
    s_nop 0
    buffer_load_dwordx4 v5, s[20:23], s72 offen lds
    s_waitcnt lgkmcnt(1)
    v_mfma_f32_16x16x32_bf16 v[176:179], v[188:191], v[232:235], v[176:179]
    v_mfma_f32_16x16x32_bf16 v[180:183], v[188:191], v[236:239], v[180:183]
    s_waitcnt vmcnt(11)
    ds_read_b128 v[184:187], v198 offset:0
    s_add_u32 m0, s91, 17408
    s_nop 0
    buffer_load_dwordx4 v6, s[20:23], s72 offen lds
    s_waitcnt lgkmcnt(1)
    v_mfma_f32_16x16x32_bf16 v[176:179], v[192:195], v[240:243], v[176:179]
    v_mfma_f32_16x16x32_bf16 v[180:183], v[192:195], v[244:247], v[180:183]
    ds_read_b128 v[188:191], v249 offset:0
    s_add_u32 s72, s81, 1622016
    s_add_u32 m0, s91, 18432
    s_nop 0
    buffer_load_dwordx4 v1, s[20:23], s72 offen lds
    s_waitcnt lgkmcnt(1)
    v_mfma_f32_16x16x32_bf16 v[168:171], v[184:187], v[200:203], 0
    v_mfma_f32_16x16x32_bf16 v[172:175], v[184:187], v[204:207], 0
    ds_read_b128 v[192:195], v198 offset:128
    s_add_u32 m0, s91, 19456
    s_nop 0
    buffer_load_dwordx4 v2, s[20:23], s72 offen lds
    s_waitcnt lgkmcnt(1)
    v_mfma_f32_16x16x32_bf16 v[168:171], v[188:191], v[208:211], v[168:171]
    v_mfma_f32_16x16x32_bf16 v[172:175], v[188:191], v[212:215], v[172:175]
    ds_read_b128 v[184:187], v249 offset:128
    s_add_u32 m0, s91, 20480
    s_nop 0
    buffer_load_dwordx4 v3, s[20:23], s72 offen lds
    s_waitcnt lgkmcnt(1)
    v_mfma_f32_16x16x32_bf16 v[168:171], v[192:195], v[216:219], v[168:171]
    v_mfma_f32_16x16x32_bf16 v[172:175], v[192:195], v[220:223], v[172:175]
    ds_read_b128 v[188:191], v198 offset:256
    s_add_u32 m0, s91, 21504
    s_nop 0
    buffer_load_dwordx4 v4, s[20:23], s72 offen lds
    s_waitcnt lgkmcnt(1)
    v_mfma_f32_16x16x32_bf16 v[168:171], v[184:187], v[224:227], v[168:171]
    v_mfma_f32_16x16x32_bf16 v[172:175], v[184:187], v[228:231], v[172:175]
    ds_read_b128 v[192:195], v249 offset:256
    v_cvt_pk_bf16_f32 v18, v176, v177
    v_cvt_pk_bf16_f32 v19, v178, v179
    v_cvt_pk_bf16_f32 v98, v180, v181
    v_cvt_pk_bf16_f32 v99, v182, v183
    s_add_u32 m0, s91, 22528
    s_nop 0
    buffer_load_dwordx4 v5, s[20:23], s72 offen lds
    s_waitcnt lgkmcnt(1)
    v_mfma_f32_16x16x32_bf16 v[168:171], v[188:191], v[232:235], v[168:171]
    v_mfma_f32_16x16x32_bf16 v[172:175], v[188:191], v[236:239], v[172:175]
    s_waitcnt vmcnt(11)
    ds_read_b128 v[184:187], v198 offset:6144
    s_add_u32 m0, s91, 23552
    s_nop 0
    buffer_load_dwordx4 v6, s[20:23], s72 offen lds
    s_waitcnt lgkmcnt(1)
    v_mfma_f32_16x16x32_bf16 v[168:171], v[192:195], v[240:243], v[168:171]
    v_mfma_f32_16x16x32_bf16 v[172:175], v[192:195], v[244:247], v[172:175]
    ds_read_b128 v[188:191], v249 offset:6144
    s_add_u32 s72, s81, 1966080
    s_add_u32 m0, s91, 0
    s_nop 0
    buffer_load_dwordx4 v1, s[20:23], s72 offen lds
    s_waitcnt lgkmcnt(1)
    v_mfma_f32_16x16x32_bf16 v[176:179], v[184:187], v[200:203], 0
    v_mfma_f32_16x16x32_bf16 v[180:183], v[184:187], v[204:207], 0
    ds_read_b128 v[192:195], v198 offset:6272
    s_add_u32 m0, s91, 1024
    s_nop 0
    buffer_load_dwordx4 v2, s[20:23], s72 offen lds
    s_waitcnt lgkmcnt(1)
    v_mfma_f32_16x16x32_bf16 v[176:179], v[188:191], v[208:211], v[176:179]
    v_mfma_f32_16x16x32_bf16 v[180:183], v[188:191], v[212:215], v[180:183]
    ds_read_b128 v[184:187], v249 offset:6272
    s_add_u32 m0, s91, 2048
    s_nop 0
    buffer_load_dwordx4 v3, s[20:23], s72 offen lds
    s_waitcnt lgkmcnt(1)
    v_mfma_f32_16x16x32_bf16 v[176:179], v[192:195], v[216:219], v[176:179]
    v_mfma_f32_16x16x32_bf16 v[180:183], v[192:195], v[220:223], v[180:183]
    ds_read_b128 v[188:191], v198 offset:6400
    s_add_u32 m0, s91, 3072
    s_nop 0
    buffer_load_dwordx4 v4, s[20:23], s72 offen lds
    s_waitcnt lgkmcnt(1)
    v_mfma_f32_16x16x32_bf16 v[176:179], v[184:187], v[224:227], v[176:179]
    v_mfma_f32_16x16x32_bf16 v[180:183], v[184:187], v[228:231], v[180:183]
    ds_read_b128 v[192:195], v249 offset:6400
    v_cvt_pk_bf16_f32 v20, v168, v169
    v_cvt_pk_bf16_f32 v21, v170, v171
    v_cvt_pk_bf16_f32 v100, v172, v173
    v_cvt_pk_bf16_f32 v101, v174, v175
    s_add_u32 m0, s91, 4096
    s_nop 0
    buffer_load_dwordx4 v5, s[20:23], s72 offen lds
    s_waitcnt lgkmcnt(1)
    v_mfma_f32_16x16x32_bf16 v[176:179], v[188:191], v[232:235], v[176:179]
    v_mfma_f32_16x16x32_bf16 v[180:183], v[188:191], v[236:239], v[180:183]
    s_waitcnt vmcnt(11)
    ds_read_b128 v[184:187], v198 offset:12288
    s_add_u32 m0, s91, 5120
    s_nop 0
    buffer_load_dwordx4 v6, s[20:23], s72 offen lds
    s_waitcnt lgkmcnt(1)
    v_mfma_f32_16x16x32_bf16 v[176:179], v[192:195], v[240:243], v[176:179]
    v_mfma_f32_16x16x32_bf16 v[180:183], v[192:195], v[244:247], v[180:183]
    ds_read_b128 v[188:191], v249 offset:12288
    s_add_u32 s72, s81, 2015232
    s_add_u32 m0, s91, 6144
    s_nop 0
    buffer_load_dwordx4 v1, s[20:23], s72 offen lds
    s_waitcnt lgkmcnt(1)
    v_mfma_f32_16x16x32_bf16 v[168:171], v[184:187], v[200:203], 0
    v_mfma_f32_16x16x32_bf16 v[172:175], v[184:187], v[204:207], 0
    ds_read_b128 v[192:195], v198 offset:12416
    s_add_u32 m0, s91, 7168
    s_nop 0
    buffer_load_dwordx4 v2, s[20:23], s72 offen lds
    s_waitcnt lgkmcnt(1)
    v_mfma_f32_16x16x32_bf16 v[168:171], v[188:191], v[208:211], v[168:171]
    v_mfma_f32_16x16x32_bf16 v[172:175], v[188:191], v[212:215], v[172:175]
    ds_read_b128 v[184:187], v249 offset:12416
    s_add_u32 m0, s91, 8192
    s_nop 0
    buffer_load_dwordx4 v3, s[20:23], s72 offen lds
    s_waitcnt lgkmcnt(1)
    v_mfma_f32_16x16x32_bf16 v[168:171], v[192:195], v[216:219], v[168:171]
    v_mfma_f32_16x16x32_bf16 v[172:175], v[192:195], v[220:223], v[172:175]
    ds_read_b128 v[188:191], v198 offset:12544
    s_add_u32 m0, s91, 9216
    s_nop 0
    buffer_load_dwordx4 v4, s[20:23], s72 offen lds
    s_waitcnt lgkmcnt(1)
    v_mfma_f32_16x16x32_bf16 v[168:171], v[184:187], v[224:227], v[168:171]
    v_mfma_f32_16x16x32_bf16 v[172:175], v[184:187], v[228:231], v[172:175]
    ds_read_b128 v[192:195], v249 offset:12544
    v_cvt_pk_bf16_f32 v22, v176, v177
    v_cvt_pk_bf16_f32 v23, v178, v179
    v_cvt_pk_bf16_f32 v102, v180, v181
    v_cvt_pk_bf16_f32 v103, v182, v183
    s_add_u32 m0, s91, 10240
    s_nop 0
    buffer_load_dwordx4 v5, s[20:23], s72 offen lds
    s_waitcnt lgkmcnt(1)
    v_mfma_f32_16x16x32_bf16 v[168:171], v[188:191], v[232:235], v[168:171]
    v_mfma_f32_16x16x32_bf16 v[172:175], v[188:191], v[236:239], v[172:175]
    s_waitcnt vmcnt(11)
    ds_read_b128 v[184:187], v198 offset:18432
    s_add_u32 m0, s91, 11264
    s_nop 0
    buffer_load_dwordx4 v6, s[20:23], s72 offen lds
    s_waitcnt lgkmcnt(1)
    v_mfma_f32_16x16x32_bf16 v[168:171], v[192:195], v[240:243], v[168:171]
    v_mfma_f32_16x16x32_bf16 v[172:175], v[192:195], v[244:247], v[172:175]
    ds_read_b128 v[188:191], v249 offset:18432
    s_add_u32 s72, s81, 2359296
    s_add_u32 m0, s91, 12288
    s_nop 0
    buffer_load_dwordx4 v1, s[20:23], s72 offen lds
    s_waitcnt lgkmcnt(1)
    v_mfma_f32_16x16x32_bf16 v[176:179], v[184:187], v[200:203], 0
    v_mfma_f32_16x16x32_bf16 v[180:183], v[184:187], v[204:207], 0
    ds_read_b128 v[192:195], v198 offset:18560
    s_add_u32 m0, s91, 13312
    s_nop 0
    buffer_load_dwordx4 v2, s[20:23], s72 offen lds
    s_waitcnt lgkmcnt(1)
    v_mfma_f32_16x16x32_bf16 v[176:179], v[188:191], v[208:211], v[176:179]
    v_mfma_f32_16x16x32_bf16 v[180:183], v[188:191], v[212:215], v[180:183]
    ds_read_b128 v[184:187], v249 offset:18560
    s_add_u32 m0, s91, 14336
    s_nop 0
    buffer_load_dwordx4 v3, s[20:23], s72 offen lds
    s_waitcnt lgkmcnt(1)
    v_mfma_f32_16x16x32_bf16 v[176:179], v[192:195], v[216:219], v[176:179]
    v_mfma_f32_16x16x32_bf16 v[180:183], v[192:195], v[220:223], v[180:183]
    ds_read_b128 v[188:191], v198 offset:18688
    s_add_u32 m0, s91, 15360
    s_nop 0
    buffer_load_dwordx4 v4, s[20:23], s72 offen lds
    s_waitcnt lgkmcnt(1)
    v_mfma_f32_16x16x32_bf16 v[176:179], v[184:187], v[224:227], v[176:179]
    v_mfma_f32_16x16x32_bf16 v[180:183], v[184:187], v[228:231], v[180:183]
    ds_read_b128 v[192:195], v249 offset:18688
    v_cvt_pk_bf16_f32 v24, v168, v169
    v_cvt_pk_bf16_f32 v25, v170, v171
    v_cvt_pk_bf16_f32 v104, v172, v173
    v_cvt_pk_bf16_f32 v105, v174, v175
    s_add_u32 m0, s91, 16384
    s_nop 0
    buffer_load_dwordx4 v5, s[20:23], s72 offen lds
    s_waitcnt lgkmcnt(1)
    v_mfma_f32_16x16x32_bf16 v[176:179], v[188:191], v[232:235], v[176:179]
    v_mfma_f32_16x16x32_bf16 v[180:183], v[188:191], v[236:239], v[180:183]
    s_waitcnt vmcnt(11)
    ds_read_b128 v[184:187], v198 offset:0
    s_add_u32 m0, s91, 17408
    s_nop 0
    buffer_load_dwordx4 v6, s[20:23], s72 offen lds
    s_waitcnt lgkmcnt(1)
    v_mfma_f32_16x16x32_bf16 v[176:179], v[192:195], v[240:243], v[176:179]
    v_mfma_f32_16x16x32_bf16 v[180:183], v[192:195], v[244:247], v[180:183]
    ds_read_b128 v[188:191], v249 offset:0
    s_add_u32 s72, s81, 2408448
    s_add_u32 m0, s91, 18432
    s_nop 0
    buffer_load_dwordx4 v1, s[20:23], s72 offen lds
    s_waitcnt lgkmcnt(1)
    v_mfma_f32_16x16x32_bf16 v[168:171], v[184:187], v[200:203], 0
    v_mfma_f32_16x16x32_bf16 v[172:175], v[184:187], v[204:207], 0
    ds_read_b128 v[192:195], v198 offset:128
    s_add_u32 m0, s91, 19456
    s_nop 0
    buffer_load_dwordx4 v2, s[20:23], s72 offen lds
    s_waitcnt lgkmcnt(1)
    v_mfma_f32_16x16x32_bf16 v[168:171], v[188:191], v[208:211], v[168:171]
    v_mfma_f32_16x16x32_bf16 v[172:175], v[188:191], v[212:215], v[172:175]
    ds_read_b128 v[184:187], v249 offset:128
    s_add_u32 m0, s91, 20480
    s_nop 0
    buffer_load_dwordx4 v3, s[20:23], s72 offen lds
    s_waitcnt lgkmcnt(1)
    v_mfma_f32_16x16x32_bf16 v[168:171], v[192:195], v[216:219], v[168:171]
    v_mfma_f32_16x16x32_bf16 v[172:175], v[192:195], v[220:223], v[172:175]
    ds_read_b128 v[188:191], v198 offset:256
    s_add_u32 m0, s91, 21504
    s_nop 0
    buffer_load_dwordx4 v4, s[20:23], s72 offen lds
    s_waitcnt lgkmcnt(1)
    v_mfma_f32_16x16x32_bf16 v[168:171], v[184:187], v[224:227], v[168:171]
    v_mfma_f32_16x16x32_bf16 v[172:175], v[184:187], v[228:231], v[172:175]
    ds_read_b128 v[192:195], v249 offset:256
    v_cvt_pk_bf16_f32 v26, v176, v177
    v_cvt_pk_bf16_f32 v27, v178, v179
    v_cvt_pk_bf16_f32 v106, v180, v181
    v_cvt_pk_bf16_f32 v107, v182, v183
    s_add_u32 m0, s91, 22528
    s_nop 0
    buffer_load_dwordx4 v5, s[20:23], s72 offen lds
    s_waitcnt lgkmcnt(1)
    v_mfma_f32_16x16x32_bf16 v[168:171], v[188:191], v[232:235], v[168:171]
    v_mfma_f32_16x16x32_bf16 v[172:175], v[188:191], v[236:239], v[172:175]
    s_waitcnt vmcnt(11)
    ds_read_b128 v[184:187], v198 offset:6144
    s_add_u32 m0, s91, 23552
    s_nop 0
    buffer_load_dwordx4 v6, s[20:23], s72 offen lds
    s_waitcnt lgkmcnt(1)
    v_mfma_f32_16x16x32_bf16 v[168:171], v[192:195], v[240:243], v[168:171]
    v_mfma_f32_16x16x32_bf16 v[172:175], v[192:195], v[244:247], v[172:175]
    ds_read_b128 v[188:191], v249 offset:6144
    s_add_u32 s72, s81, 2752512
    s_add_u32 m0, s91, 0
    s_nop 0
    buffer_load_dwordx4 v1, s[20:23], s72 offen lds
    s_waitcnt lgkmcnt(1)
    v_mfma_f32_16x16x32_bf16 v[176:179], v[184:187], v[200:203], 0
    v_mfma_f32_16x16x32_bf16 v[180:183], v[184:187], v[204:207], 0
    ds_read_b128 v[192:195], v198 offset:6272
    s_add_u32 m0, s91, 1024
    s_nop 0
    buffer_load_dwordx4 v2, s[20:23], s72 offen lds
    s_waitcnt lgkmcnt(1)
    v_mfma_f32_16x16x32_bf16 v[176:179], v[188:191], v[208:211], v[176:179]
    v_mfma_f32_16x16x32_bf16 v[180:183], v[188:191], v[212:215], v[180:183]
    ds_read_b128 v[184:187], v249 offset:6272
    s_add_u32 m0, s91, 2048
    s_nop 0
    buffer_load_dwordx4 v3, s[20:23], s72 offen lds
    s_waitcnt lgkmcnt(1)
    v_mfma_f32_16x16x32_bf16 v[176:179], v[192:195], v[216:219], v[176:179]
    v_mfma_f32_16x16x32_bf16 v[180:183], v[192:195], v[220:223], v[180:183]
    ds_read_b128 v[188:191], v198 offset:6400
    s_add_u32 m0, s91, 3072
    s_nop 0
    buffer_load_dwordx4 v4, s[20:23], s72 offen lds
    s_waitcnt lgkmcnt(1)
    v_mfma_f32_16x16x32_bf16 v[176:179], v[184:187], v[224:227], v[176:179]
    v_mfma_f32_16x16x32_bf16 v[180:183], v[184:187], v[228:231], v[180:183]
    ds_read_b128 v[192:195], v249 offset:6400
    v_cvt_pk_bf16_f32 v28, v168, v169
    v_cvt_pk_bf16_f32 v29, v170, v171
    v_cvt_pk_bf16_f32 v108, v172, v173
    v_cvt_pk_bf16_f32 v109, v174, v175
    s_add_u32 m0, s91, 4096
    s_nop 0
    buffer_load_dwordx4 v5, s[20:23], s72 offen lds
    s_waitcnt lgkmcnt(1)
    v_mfma_f32_16x16x32_bf16 v[176:179], v[188:191], v[232:235], v[176:179]
    v_mfma_f32_16x16x32_bf16 v[180:183], v[188:191], v[236:239], v[180:183]
    s_waitcnt vmcnt(11)
    ds_read_b128 v[184:187], v198 offset:12288
    s_add_u32 m0, s91, 5120
    s_nop 0
    buffer_load_dwordx4 v6, s[20:23], s72 offen lds
    s_waitcnt lgkmcnt(1)
    v_mfma_f32_16x16x32_bf16 v[176:179], v[192:195], v[240:243], v[176:179]
    v_mfma_f32_16x16x32_bf16 v[180:183], v[192:195], v[244:247], v[180:183]
    ds_read_b128 v[188:191], v249 offset:12288
    s_add_u32 s72, s81, 2801664
    s_add_u32 m0, s91, 6144
    s_nop 0
    buffer_load_dwordx4 v1, s[20:23], s72 offen lds
    s_waitcnt lgkmcnt(1)
    v_mfma_f32_16x16x32_bf16 v[168:171], v[184:187], v[200:203], 0
    v_mfma_f32_16x16x32_bf16 v[172:175], v[184:187], v[204:207], 0
    ds_read_b128 v[192:195], v198 offset:12416
    s_add_u32 m0, s91, 7168
    s_nop 0
    buffer_load_dwordx4 v2, s[20:23], s72 offen lds
    s_waitcnt lgkmcnt(1)
    v_mfma_f32_16x16x32_bf16 v[168:171], v[188:191], v[208:211], v[168:171]
    v_mfma_f32_16x16x32_bf16 v[172:175], v[188:191], v[212:215], v[172:175]
    ds_read_b128 v[184:187], v249 offset:12416
    s_add_u32 m0, s91, 8192
    s_nop 0
    buffer_load_dwordx4 v3, s[20:23], s72 offen lds
    s_waitcnt lgkmcnt(1)
    v_mfma_f32_16x16x32_bf16 v[168:171], v[192:195], v[216:219], v[168:171]
    v_mfma_f32_16x16x32_bf16 v[172:175], v[192:195], v[220:223], v[172:175]
    ds_read_b128 v[188:191], v198 offset:12544
    s_add_u32 m0, s91, 9216
    s_nop 0
    buffer_load_dwordx4 v4, s[20:23], s72 offen lds
    s_waitcnt lgkmcnt(1)
    v_mfma_f32_16x16x32_bf16 v[168:171], v[184:187], v[224:227], v[168:171]
    v_mfma_f32_16x16x32_bf16 v[172:175], v[184:187], v[228:231], v[172:175]
    ds_read_b128 v[192:195], v249 offset:12544
    v_cvt_pk_bf16_f32 v30, v176, v177
    v_cvt_pk_bf16_f32 v31, v178, v179
    v_cvt_pk_bf16_f32 v110, v180, v181
    v_cvt_pk_bf16_f32 v111, v182, v183
    s_add_u32 m0, s91, 10240
    s_nop 0
    buffer_load_dwordx4 v5, s[20:23], s72 offen lds
    s_waitcnt lgkmcnt(1)
    v_mfma_f32_16x16x32_bf16 v[168:171], v[188:191], v[232:235], v[168:171]
    v_mfma_f32_16x16x32_bf16 v[172:175], v[188:191], v[236:239], v[172:175]
    s_waitcnt vmcnt(11)
    ds_read_b128 v[184:187], v198 offset:18432
    s_add_u32 m0, s91, 11264
    s_nop 0
    buffer_load_dwordx4 v6, s[20:23], s72 offen lds
    s_waitcnt lgkmcnt(1)
    v_mfma_f32_16x16x32_bf16 v[168:171], v[192:195], v[240:243], v[168:171]
    v_mfma_f32_16x16x32_bf16 v[172:175], v[192:195], v[244:247], v[172:175]
    ds_read_b128 v[188:191], v249 offset:18432
    s_add_u32 s72, s81, 3145728
    s_add_u32 m0, s91, 12288
    s_nop 0
    buffer_load_dwordx4 v1, s[20:23], s72 offen lds
    s_waitcnt lgkmcnt(1)
    v_mfma_f32_16x16x32_bf16 v[176:179], v[184:187], v[200:203], 0
    v_mfma_f32_16x16x32_bf16 v[180:183], v[184:187], v[204:207], 0
    ds_read_b128 v[192:195], v198 offset:18560
    s_add_u32 m0, s91, 13312
    s_nop 0
    buffer_load_dwordx4 v2, s[20:23], s72 offen lds
    s_waitcnt lgkmcnt(1)
    v_mfma_f32_16x16x32_bf16 v[176:179], v[188:191], v[208:211], v[176:179]
    v_mfma_f32_16x16x32_bf16 v[180:183], v[188:191], v[212:215], v[180:183]
    ds_read_b128 v[184:187], v249 offset:18560
    s_add_u32 m0, s91, 14336
    s_nop 0
    buffer_load_dwordx4 v3, s[20:23], s72 offen lds
    s_waitcnt lgkmcnt(1)
    v_mfma_f32_16x16x32_bf16 v[176:179], v[192:195], v[216:219], v[176:179]
    v_mfma_f32_16x16x32_bf16 v[180:183], v[192:195], v[220:223], v[180:183]
    ds_read_b128 v[188:191], v198 offset:18688
    s_add_u32 m0, s91, 15360
    s_nop 0
    buffer_load_dwordx4 v4, s[20:23], s72 offen lds
    s_waitcnt lgkmcnt(1)
    v_mfma_f32_16x16x32_bf16 v[176:179], v[184:187], v[224:227], v[176:179]
    v_mfma_f32_16x16x32_bf16 v[180:183], v[184:187], v[228:231], v[180:183]
    ds_read_b128 v[192:195], v249 offset:18688
    v_cvt_pk_bf16_f32 v32, v168, v169
    v_cvt_pk_bf16_f32 v33, v170, v171
    v_cvt_pk_bf16_f32 v112, v172, v173
    v_cvt_pk_bf16_f32 v113, v174, v175
    s_add_u32 m0, s91, 16384
    s_nop 0
    buffer_load_dwordx4 v5, s[20:23], s72 offen lds
    s_waitcnt lgkmcnt(1)
    v_mfma_f32_16x16x32_bf16 v[176:179], v[188:191], v[232:235], v[176:179]
    v_mfma_f32_16x16x32_bf16 v[180:183], v[188:191], v[236:239], v[180:183]
    s_waitcnt vmcnt(11)
    ds_read_b128 v[184:187], v198 offset:0
    s_add_u32 m0, s91, 17408
    s_nop 0
    buffer_load_dwordx4 v6, s[20:23], s72 offen lds
    s_waitcnt lgkmcnt(1)
    v_mfma_f32_16x16x32_bf16 v[176:179], v[192:195], v[240:243], v[176:179]
    v_mfma_f32_16x16x32_bf16 v[180:183], v[192:195], v[244:247], v[180:183]
    ds_read_b128 v[188:191], v249 offset:0
    s_add_u32 s72, s81, 3194880
    s_add_u32 m0, s91, 18432
    s_nop 0
    buffer_load_dwordx4 v1, s[20:23], s72 offen lds
    s_waitcnt lgkmcnt(1)
    v_mfma_f32_16x16x32_bf16 v[168:171], v[184:187], v[200:203], 0
    v_mfma_f32_16x16x32_bf16 v[172:175], v[184:187], v[204:207], 0
    ds_read_b128 v[192:195], v198 offset:128
    s_add_u32 m0, s91, 19456
    s_nop 0
    buffer_load_dwordx4 v2, s[20:23], s72 offen lds
    s_waitcnt lgkmcnt(1)
    v_mfma_f32_16x16x32_bf16 v[168:171], v[188:191], v[208:211], v[168:171]
    v_mfma_f32_16x16x32_bf16 v[172:175], v[188:191], v[212:215], v[172:175]
    ds_read_b128 v[184:187], v249 offset:128
    s_add_u32 m0, s91, 20480
    s_nop 0
    buffer_load_dwordx4 v3, s[20:23], s72 offen lds
    s_waitcnt lgkmcnt(1)
    v_mfma_f32_16x16x32_bf16 v[168:171], v[192:195], v[216:219], v[168:171]
    v_mfma_f32_16x16x32_bf16 v[172:175], v[192:195], v[220:223], v[172:175]
    ds_read_b128 v[188:191], v198 offset:256
    s_add_u32 m0, s91, 21504
    s_nop 0
    buffer_load_dwordx4 v4, s[20:23], s72 offen lds
    s_waitcnt lgkmcnt(1)
    v_mfma_f32_16x16x32_bf16 v[168:171], v[184:187], v[224:227], v[168:171]
    v_mfma_f32_16x16x32_bf16 v[172:175], v[184:187], v[228:231], v[172:175]
    ds_read_b128 v[192:195], v249 offset:256
    v_cvt_pk_bf16_f32 v34, v176, v177
    v_cvt_pk_bf16_f32 v35, v178, v179
    v_cvt_pk_bf16_f32 v114, v180, v181
    v_cvt_pk_bf16_f32 v115, v182, v183
    s_add_u32 m0, s91, 22528
    s_nop 0
    buffer_load_dwordx4 v5, s[20:23], s72 offen lds
    s_waitcnt lgkmcnt(1)
    v_mfma_f32_16x16x32_bf16 v[168:171], v[188:191], v[232:235], v[168:171]
    v_mfma_f32_16x16x32_bf16 v[172:175], v[188:191], v[236:239], v[172:175]
    s_waitcnt vmcnt(11)
    ds_read_b128 v[184:187], v198 offset:6144
    s_add_u32 m0, s91, 23552
    s_nop 0
    buffer_load_dwordx4 v6, s[20:23], s72 offen lds
    s_waitcnt lgkmcnt(1)
    v_mfma_f32_16x16x32_bf16 v[168:171], v[192:195], v[240:243], v[168:171]
    v_mfma_f32_16x16x32_bf16 v[172:175], v[192:195], v[244:247], v[172:175]
    ds_read_b128 v[188:191], v249 offset:6144
    s_add_u32 s72, s81, 3538944
    s_add_u32 m0, s91, 0
    s_nop 0
    buffer_load_dwordx4 v1, s[20:23], s72 offen lds
    s_waitcnt lgkmcnt(1)
    v_mfma_f32_16x16x32_bf16 v[176:179], v[184:187], v[200:203], 0
    v_mfma_f32_16x16x32_bf16 v[180:183], v[184:187], v[204:207], 0
    ds_read_b128 v[192:195], v198 offset:6272
    s_add_u32 m0, s91, 1024
    s_nop 0
    buffer_load_dwordx4 v2, s[20:23], s72 offen lds
    s_waitcnt lgkmcnt(1)
    v_mfma_f32_16x16x32_bf16 v[176:179], v[188:191], v[208:211], v[176:179]
    v_mfma_f32_16x16x32_bf16 v[180:183], v[188:191], v[212:215], v[180:183]
    ds_read_b128 v[184:187], v249 offset:6272
    s_add_u32 m0, s91, 2048
    s_nop 0
    buffer_load_dwordx4 v3, s[20:23], s72 offen lds
    s_waitcnt lgkmcnt(1)
    v_mfma_f32_16x16x32_bf16 v[176:179], v[192:195], v[216:219], v[176:179]
    v_mfma_f32_16x16x32_bf16 v[180:183], v[192:195], v[220:223], v[180:183]
    ds_read_b128 v[188:191], v198 offset:6400
    s_add_u32 m0, s91, 3072
    s_nop 0
    buffer_load_dwordx4 v4, s[20:23], s72 offen lds
    s_waitcnt lgkmcnt(1)
    v_mfma_f32_16x16x32_bf16 v[176:179], v[184:187], v[224:227], v[176:179]
    v_mfma_f32_16x16x32_bf16 v[180:183], v[184:187], v[228:231], v[180:183]
    ds_read_b128 v[192:195], v249 offset:6400
    v_cvt_pk_bf16_f32 v36, v168, v169
    v_cvt_pk_bf16_f32 v37, v170, v171
    v_cvt_pk_bf16_f32 v116, v172, v173
    v_cvt_pk_bf16_f32 v117, v174, v175
    s_add_u32 m0, s91, 4096
    s_nop 0
    buffer_load_dwordx4 v5, s[20:23], s72 offen lds
    s_waitcnt lgkmcnt(1)
    v_mfma_f32_16x16x32_bf16 v[176:179], v[188:191], v[232:235], v[176:179]
    v_mfma_f32_16x16x32_bf16 v[180:183], v[188:191], v[236:239], v[180:183]
    s_waitcnt vmcnt(11)
    ds_read_b128 v[184:187], v198 offset:12288
    s_add_u32 m0, s91, 5120
    s_nop 0
    buffer_load_dwordx4 v6, s[20:23], s72 offen lds
    s_waitcnt lgkmcnt(1)
    v_mfma_f32_16x16x32_bf16 v[176:179], v[192:195], v[240:243], v[176:179]
    v_mfma_f32_16x16x32_bf16 v[180:183], v[192:195], v[244:247], v[180:183]
    ds_read_b128 v[188:191], v249 offset:12288
    s_add_u32 s72, s81, 3588096
    s_add_u32 m0, s91, 6144
    s_nop 0
    buffer_load_dwordx4 v1, s[20:23], s72 offen lds
    s_waitcnt lgkmcnt(1)
    v_mfma_f32_16x16x32_bf16 v[168:171], v[184:187], v[200:203], 0
    v_mfma_f32_16x16x32_bf16 v[172:175], v[184:187], v[204:207], 0
    ds_read_b128 v[192:195], v198 offset:12416
    s_add_u32 m0, s91, 7168
    s_nop 0
    buffer_load_dwordx4 v2, s[20:23], s72 offen lds
    s_waitcnt lgkmcnt(1)
    v_mfma_f32_16x16x32_bf16 v[168:171], v[188:191], v[208:211], v[168:171]
    v_mfma_f32_16x16x32_bf16 v[172:175], v[188:191], v[212:215], v[172:175]
    ds_read_b128 v[184:187], v249 offset:12416
    s_add_u32 m0, s91, 8192
    s_nop 0
    buffer_load_dwordx4 v3, s[20:23], s72 offen lds
    s_waitcnt lgkmcnt(1)
    v_mfma_f32_16x16x32_bf16 v[168:171], v[192:195], v[216:219], v[168:171]
    v_mfma_f32_16x16x32_bf16 v[172:175], v[192:195], v[220:223], v[172:175]
    ds_read_b128 v[188:191], v198 offset:12544
    s_add_u32 m0, s91, 9216
    s_nop 0
    buffer_load_dwordx4 v4, s[20:23], s72 offen lds
    s_waitcnt lgkmcnt(1)
    v_mfma_f32_16x16x32_bf16 v[168:171], v[184:187], v[224:227], v[168:171]
    v_mfma_f32_16x16x32_bf16 v[172:175], v[184:187], v[228:231], v[172:175]
    ds_read_b128 v[192:195], v249 offset:12544
    v_cvt_pk_bf16_f32 v38, v176, v177
    v_cvt_pk_bf16_f32 v39, v178, v179
    v_cvt_pk_bf16_f32 v118, v180, v181
    v_cvt_pk_bf16_f32 v119, v182, v183
    s_add_u32 m0, s91, 10240
    s_nop 0
    buffer_load_dwordx4 v5, s[20:23], s72 offen lds
    s_waitcnt lgkmcnt(1)
    v_mfma_f32_16x16x32_bf16 v[168:171], v[188:191], v[232:235], v[168:171]
    v_mfma_f32_16x16x32_bf16 v[172:175], v[188:191], v[236:239], v[172:175]
    s_waitcnt vmcnt(11)
    ds_read_b128 v[184:187], v198 offset:18432
    s_add_u32 m0, s91, 11264
    s_nop 0
    buffer_load_dwordx4 v6, s[20:23], s72 offen lds
    s_waitcnt lgkmcnt(1)
    v_mfma_f32_16x16x32_bf16 v[168:171], v[192:195], v[240:243], v[168:171]
    v_mfma_f32_16x16x32_bf16 v[172:175], v[192:195], v[244:247], v[172:175]
    ds_read_b128 v[188:191], v249 offset:18432
    s_add_u32 s72, s81, 3932160
    s_add_u32 m0, s91, 12288
    s_nop 0
    buffer_load_dwordx4 v1, s[20:23], s72 offen lds
    s_waitcnt lgkmcnt(1)
    v_mfma_f32_16x16x32_bf16 v[176:179], v[184:187], v[200:203], 0
    v_mfma_f32_16x16x32_bf16 v[180:183], v[184:187], v[204:207], 0
    ds_read_b128 v[192:195], v198 offset:18560
    s_add_u32 m0, s91, 13312
    s_nop 0
    buffer_load_dwordx4 v2, s[20:23], s72 offen lds
    s_waitcnt lgkmcnt(1)
    v_mfma_f32_16x16x32_bf16 v[176:179], v[188:191], v[208:211], v[176:179]
    v_mfma_f32_16x16x32_bf16 v[180:183], v[188:191], v[212:215], v[180:183]
    ds_read_b128 v[184:187], v249 offset:18560
    s_add_u32 m0, s91, 14336
    s_nop 0
    buffer_load_dwordx4 v3, s[20:23], s72 offen lds
    s_waitcnt lgkmcnt(1)
    v_mfma_f32_16x16x32_bf16 v[176:179], v[192:195], v[216:219], v[176:179]
    v_mfma_f32_16x16x32_bf16 v[180:183], v[192:195], v[220:223], v[180:183]
    ds_read_b128 v[188:191], v198 offset:18688
    s_add_u32 m0, s91, 15360
    s_nop 0
    buffer_load_dwordx4 v4, s[20:23], s72 offen lds
    s_waitcnt lgkmcnt(1)
    v_mfma_f32_16x16x32_bf16 v[176:179], v[184:187], v[224:227], v[176:179]
    v_mfma_f32_16x16x32_bf16 v[180:183], v[184:187], v[228:231], v[180:183]
    ds_read_b128 v[192:195], v249 offset:18688
    v_cvt_pk_bf16_f32 v40, v168, v169
    v_cvt_pk_bf16_f32 v41, v170, v171
    v_cvt_pk_bf16_f32 v120, v172, v173
    v_cvt_pk_bf16_f32 v121, v174, v175
    s_add_u32 m0, s91, 16384
    s_nop 0
    buffer_load_dwordx4 v5, s[20:23], s72 offen lds
    s_waitcnt lgkmcnt(1)
    v_mfma_f32_16x16x32_bf16 v[176:179], v[188:191], v[232:235], v[176:179]
    v_mfma_f32_16x16x32_bf16 v[180:183], v[188:191], v[236:239], v[180:183]
    s_waitcnt vmcnt(11)
    ds_read_b128 v[184:187], v198 offset:0
    s_add_u32 m0, s91, 17408
    s_nop 0
    buffer_load_dwordx4 v6, s[20:23], s72 offen lds
    s_waitcnt lgkmcnt(1)
    v_mfma_f32_16x16x32_bf16 v[176:179], v[192:195], v[240:243], v[176:179]
    v_mfma_f32_16x16x32_bf16 v[180:183], v[192:195], v[244:247], v[180:183]
    ds_read_b128 v[188:191], v249 offset:0
    s_add_u32 s72, s81, 3981312
    s_add_u32 m0, s91, 18432
    s_nop 0
    buffer_load_dwordx4 v1, s[20:23], s72 offen lds
    s_waitcnt lgkmcnt(1)
    v_mfma_f32_16x16x32_bf16 v[168:171], v[184:187], v[200:203], 0
    v_mfma_f32_16x16x32_bf16 v[172:175], v[184:187], v[204:207], 0
    ds_read_b128 v[192:195], v198 offset:128
    s_add_u32 m0, s91, 19456
    s_nop 0
    buffer_load_dwordx4 v2, s[20:23], s72 offen lds
    s_waitcnt lgkmcnt(1)
    v_mfma_f32_16x16x32_bf16 v[168:171], v[188:191], v[208:211], v[168:171]
    v_mfma_f32_16x16x32_bf16 v[172:175], v[188:191], v[212:215], v[172:175]
    ds_read_b128 v[184:187], v249 offset:128
    s_add_u32 m0, s91, 20480
    s_nop 0
    buffer_load_dwordx4 v3, s[20:23], s72 offen lds
    s_waitcnt lgkmcnt(1)
    v_mfma_f32_16x16x32_bf16 v[168:171], v[192:195], v[216:219], v[168:171]
    v_mfma_f32_16x16x32_bf16 v[172:175], v[192:195], v[220:223], v[172:175]
    ds_read_b128 v[188:191], v198 offset:256
    s_add_u32 m0, s91, 21504
    s_nop 0
    buffer_load_dwordx4 v4, s[20:23], s72 offen lds
    s_waitcnt lgkmcnt(1)
    v_mfma_f32_16x16x32_bf16 v[168:171], v[184:187], v[224:227], v[168:171]
    v_mfma_f32_16x16x32_bf16 v[172:175], v[184:187], v[228:231], v[172:175]
    ds_read_b128 v[192:195], v249 offset:256
    v_cvt_pk_bf16_f32 v42, v176, v177
    v_cvt_pk_bf16_f32 v43, v178, v179
    v_cvt_pk_bf16_f32 v122, v180, v181
    v_cvt_pk_bf16_f32 v123, v182, v183
    s_add_u32 m0, s91, 22528
    s_nop 0
    buffer_load_dwordx4 v5, s[20:23], s72 offen lds
    s_waitcnt lgkmcnt(1)
    v_mfma_f32_16x16x32_bf16 v[168:171], v[188:191], v[232:235], v[168:171]
    v_mfma_f32_16x16x32_bf16 v[172:175], v[188:191], v[236:239], v[172:175]
    s_waitcnt vmcnt(11)
    ds_read_b128 v[184:187], v198 offset:6144
    s_add_u32 m0, s91, 23552
    s_nop 0
    buffer_load_dwordx4 v6, s[20:23], s72 offen lds
    s_waitcnt lgkmcnt(1)
    v_mfma_f32_16x16x32_bf16 v[168:171], v[192:195], v[240:243], v[168:171]
    v_mfma_f32_16x16x32_bf16 v[172:175], v[192:195], v[244:247], v[172:175]
    ds_read_b128 v[188:191], v249 offset:6144
    s_add_u32 s72, s81, 4325376
    s_add_u32 m0, s91, 0
    s_nop 0
    buffer_load_dwordx4 v1, s[20:23], s72 offen lds
    s_waitcnt lgkmcnt(1)
    v_mfma_f32_16x16x32_bf16 v[176:179], v[184:187], v[200:203], 0
    v_mfma_f32_16x16x32_bf16 v[180:183], v[184:187], v[204:207], 0
    ds_read_b128 v[192:195], v198 offset:6272
    s_add_u32 m0, s91, 1024
    s_nop 0
    buffer_load_dwordx4 v2, s[20:23], s72 offen lds
    s_waitcnt lgkmcnt(1)
    v_mfma_f32_16x16x32_bf16 v[176:179], v[188:191], v[208:211], v[176:179]
    v_mfma_f32_16x16x32_bf16 v[180:183], v[188:191], v[212:215], v[180:183]
    ds_read_b128 v[184:187], v249 offset:6272
    s_add_u32 m0, s91, 2048
    s_nop 0
    buffer_load_dwordx4 v3, s[20:23], s72 offen lds
    s_waitcnt lgkmcnt(1)
    v_mfma_f32_16x16x32_bf16 v[176:179], v[192:195], v[216:219], v[176:179]
    v_mfma_f32_16x16x32_bf16 v[180:183], v[192:195], v[220:223], v[180:183]
    ds_read_b128 v[188:191], v198 offset:6400
    s_add_u32 m0, s91, 3072
    s_nop 0
    buffer_load_dwordx4 v4, s[20:23], s72 offen lds
    s_waitcnt lgkmcnt(1)
    v_mfma_f32_16x16x32_bf16 v[176:179], v[184:187], v[224:227], v[176:179]
    v_mfma_f32_16x16x32_bf16 v[180:183], v[184:187], v[228:231], v[180:183]
    ds_read_b128 v[192:195], v249 offset:6400
    v_cvt_pk_bf16_f32 v44, v168, v169
    v_cvt_pk_bf16_f32 v45, v170, v171
    v_cvt_pk_bf16_f32 v124, v172, v173
    v_cvt_pk_bf16_f32 v125, v174, v175
    s_add_u32 m0, s91, 4096
    s_nop 0
    buffer_load_dwordx4 v5, s[20:23], s72 offen lds
    s_waitcnt lgkmcnt(1)
    v_mfma_f32_16x16x32_bf16 v[176:179], v[188:191], v[232:235], v[176:179]
    v_mfma_f32_16x16x32_bf16 v[180:183], v[188:191], v[236:239], v[180:183]
    s_waitcnt vmcnt(11)
    ds_read_b128 v[184:187], v198 offset:12288
    s_add_u32 m0, s91, 5120
    s_nop 0
    buffer_load_dwordx4 v6, s[20:23], s72 offen lds
    s_waitcnt lgkmcnt(1)
    v_mfma_f32_16x16x32_bf16 v[176:179], v[192:195], v[240:243], v[176:179]
    v_mfma_f32_16x16x32_bf16 v[180:183], v[192:195], v[244:247], v[180:183]
    ds_read_b128 v[188:191], v249 offset:12288
    s_add_u32 s72, s81, 4374528
    s_add_u32 m0, s91, 6144
    s_nop 0
    buffer_load_dwordx4 v1, s[20:23], s72 offen lds
    s_waitcnt lgkmcnt(1)
    v_mfma_f32_16x16x32_bf16 v[168:171], v[184:187], v[200:203], 0
    v_mfma_f32_16x16x32_bf16 v[172:175], v[184:187], v[204:207], 0
    ds_read_b128 v[192:195], v198 offset:12416
    s_add_u32 m0, s91, 7168
    s_nop 0
    buffer_load_dwordx4 v2, s[20:23], s72 offen lds
    s_waitcnt lgkmcnt(1)
    v_mfma_f32_16x16x32_bf16 v[168:171], v[188:191], v[208:211], v[168:171]
    v_mfma_f32_16x16x32_bf16 v[172:175], v[188:191], v[212:215], v[172:175]
    ds_read_b128 v[184:187], v249 offset:12416
    s_add_u32 m0, s91, 8192
    s_nop 0
    buffer_load_dwordx4 v3, s[20:23], s72 offen lds
    s_waitcnt lgkmcnt(1)
    v_mfma_f32_16x16x32_bf16 v[168:171], v[192:195], v[216:219], v[168:171]
    v_mfma_f32_16x16x32_bf16 v[172:175], v[192:195], v[220:223], v[172:175]
    ds_read_b128 v[188:191], v198 offset:12544
    s_add_u32 m0, s91, 9216
    s_nop 0
    buffer_load_dwordx4 v4, s[20:23], s72 offen lds
    s_waitcnt lgkmcnt(1)
    v_mfma_f32_16x16x32_bf16 v[168:171], v[184:187], v[224:227], v[168:171]
    v_mfma_f32_16x16x32_bf16 v[172:175], v[184:187], v[228:231], v[172:175]
    ds_read_b128 v[192:195], v249 offset:12544
    v_cvt_pk_bf16_f32 v46, v176, v177
    v_cvt_pk_bf16_f32 v47, v178, v179
    v_cvt_pk_bf16_f32 v126, v180, v181
    v_cvt_pk_bf16_f32 v127, v182, v183
    s_add_u32 m0, s91, 10240
    s_nop 0
    buffer_load_dwordx4 v5, s[20:23], s72 offen lds
    s_waitcnt lgkmcnt(1)
    v_mfma_f32_16x16x32_bf16 v[168:171], v[188:191], v[232:235], v[168:171]
    v_mfma_f32_16x16x32_bf16 v[172:175], v[188:191], v[236:239], v[172:175]
    s_waitcnt vmcnt(11)
    ds_read_b128 v[184:187], v198 offset:18432
    s_add_u32 m0, s91, 11264
    s_nop 0
    buffer_load_dwordx4 v6, s[20:23], s72 offen lds
    s_waitcnt lgkmcnt(1)
    v_mfma_f32_16x16x32_bf16 v[168:171], v[192:195], v[240:243], v[168:171]
    v_mfma_f32_16x16x32_bf16 v[172:175], v[192:195], v[244:247], v[172:175]
    ds_read_b128 v[188:191], v249 offset:18432
    s_add_u32 s72, s81, 4718592
    s_add_u32 m0, s91, 12288
    s_nop 0
    buffer_load_dwordx4 v1, s[20:23], s72 offen lds
    s_waitcnt lgkmcnt(1)
    v_mfma_f32_16x16x32_bf16 v[176:179], v[184:187], v[200:203], 0
    v_mfma_f32_16x16x32_bf16 v[180:183], v[184:187], v[204:207], 0
    ds_read_b128 v[192:195], v198 offset:18560
    s_add_u32 m0, s91, 13312
    s_nop 0
    buffer_load_dwordx4 v2, s[20:23], s72 offen lds
    s_waitcnt lgkmcnt(1)
    v_mfma_f32_16x16x32_bf16 v[176:179], v[188:191], v[208:211], v[176:179]
    v_mfma_f32_16x16x32_bf16 v[180:183], v[188:191], v[212:215], v[180:183]
    ds_read_b128 v[184:187], v249 offset:18560
    s_add_u32 m0, s91, 14336
    s_nop 0
    buffer_load_dwordx4 v3, s[20:23], s72 offen lds
    s_waitcnt lgkmcnt(1)
    v_mfma_f32_16x16x32_bf16 v[176:179], v[192:195], v[216:219], v[176:179]
    v_mfma_f32_16x16x32_bf16 v[180:183], v[192:195], v[220:223], v[180:183]
    ds_read_b128 v[188:191], v198 offset:18688
    s_add_u32 m0, s91, 15360
    s_nop 0
    buffer_load_dwordx4 v4, s[20:23], s72 offen lds
    s_waitcnt lgkmcnt(1)
    v_mfma_f32_16x16x32_bf16 v[176:179], v[184:187], v[224:227], v[176:179]
    v_mfma_f32_16x16x32_bf16 v[180:183], v[184:187], v[228:231], v[180:183]
    ds_read_b128 v[192:195], v249 offset:18688
    v_cvt_pk_bf16_f32 v48, v168, v169
    v_cvt_pk_bf16_f32 v49, v170, v171
    v_cvt_pk_bf16_f32 v128, v172, v173
    v_cvt_pk_bf16_f32 v129, v174, v175
    s_add_u32 m0, s91, 16384
    s_nop 0
    buffer_load_dwordx4 v5, s[20:23], s72 offen lds
    s_waitcnt lgkmcnt(1)
    v_mfma_f32_16x16x32_bf16 v[176:179], v[188:191], v[232:235], v[176:179]
    v_mfma_f32_16x16x32_bf16 v[180:183], v[188:191], v[236:239], v[180:183]
    s_waitcnt vmcnt(11)
    ds_read_b128 v[184:187], v198 offset:0
    s_add_u32 m0, s91, 17408
    s_nop 0
    buffer_load_dwordx4 v6, s[20:23], s72 offen lds
    s_waitcnt lgkmcnt(1)
    v_mfma_f32_16x16x32_bf16 v[176:179], v[192:195], v[240:243], v[176:179]
    v_mfma_f32_16x16x32_bf16 v[180:183], v[192:195], v[244:247], v[180:183]
    ds_read_b128 v[188:191], v249 offset:0
    s_add_u32 s72, s81, 4767744
    s_add_u32 m0, s91, 18432
    s_nop 0
    buffer_load_dwordx4 v1, s[20:23], s72 offen lds
    s_waitcnt lgkmcnt(1)
    v_mfma_f32_16x16x32_bf16 v[168:171], v[184:187], v[200:203], 0
    v_mfma_f32_16x16x32_bf16 v[172:175], v[184:187], v[204:207], 0
    ds_read_b128 v[192:195], v198 offset:128
    s_add_u32 m0, s91, 19456
    s_nop 0
    buffer_load_dwordx4 v2, s[20:23], s72 offen lds
    s_waitcnt lgkmcnt(1)
    v_mfma_f32_16x16x32_bf16 v[168:171], v[188:191], v[208:211], v[168:171]
    v_mfma_f32_16x16x32_bf16 v[172:175], v[188:191], v[212:215], v[172:175]
    ds_read_b128 v[184:187], v249 offset:128
    s_add_u32 m0, s91, 20480
    s_nop 0
    buffer_load_dwordx4 v3, s[20:23], s72 offen lds
    s_waitcnt lgkmcnt(1)
    v_mfma_f32_16x16x32_bf16 v[168:171], v[192:195], v[216:219], v[168:171]
    v_mfma_f32_16x16x32_bf16 v[172:175], v[192:195], v[220:223], v[172:175]
    ds_read_b128 v[188:191], v198 offset:256
    s_add_u32 m0, s91, 21504
    s_nop 0
    buffer_load_dwordx4 v4, s[20:23], s72 offen lds
    s_waitcnt lgkmcnt(1)
    v_mfma_f32_16x16x32_bf16 v[168:171], v[184:187], v[224:227], v[168:171]
    v_mfma_f32_16x16x32_bf16 v[172:175], v[184:187], v[228:231], v[172:175]
    ds_read_b128 v[192:195], v249 offset:256
    v_cvt_pk_bf16_f32 v50, v176, v177
    v_cvt_pk_bf16_f32 v51, v178, v179
    v_cvt_pk_bf16_f32 v130, v180, v181
    v_cvt_pk_bf16_f32 v131, v182, v183
    s_add_u32 m0, s91, 22528
    s_nop 0
    buffer_load_dwordx4 v5, s[20:23], s72 offen lds
    s_waitcnt lgkmcnt(1)
    v_mfma_f32_16x16x32_bf16 v[168:171], v[188:191], v[232:235], v[168:171]
    v_mfma_f32_16x16x32_bf16 v[172:175], v[188:191], v[236:239], v[172:175]
    s_waitcnt vmcnt(11)
    ds_read_b128 v[184:187], v198 offset:6144
    s_add_u32 m0, s91, 23552
    s_nop 0
    buffer_load_dwordx4 v6, s[20:23], s72 offen lds
    s_waitcnt lgkmcnt(1)
    v_mfma_f32_16x16x32_bf16 v[168:171], v[192:195], v[240:243], v[168:171]
    v_mfma_f32_16x16x32_bf16 v[172:175], v[192:195], v[244:247], v[172:175]
    ds_read_b128 v[188:191], v249 offset:6144
    s_add_u32 s72, s81, 5111808
    s_add_u32 m0, s91, 0
    s_nop 0
    buffer_load_dwordx4 v1, s[20:23], s72 offen lds
    s_waitcnt lgkmcnt(1)
    v_mfma_f32_16x16x32_bf16 v[176:179], v[184:187], v[200:203], 0
    v_mfma_f32_16x16x32_bf16 v[180:183], v[184:187], v[204:207], 0
    ds_read_b128 v[192:195], v198 offset:6272
    s_add_u32 m0, s91, 1024
    s_nop 0
    buffer_load_dwordx4 v2, s[20:23], s72 offen lds
    s_waitcnt lgkmcnt(1)
    v_mfma_f32_16x16x32_bf16 v[176:179], v[188:191], v[208:211], v[176:179]
    v_mfma_f32_16x16x32_bf16 v[180:183], v[188:191], v[212:215], v[180:183]
    ds_read_b128 v[184:187], v249 offset:6272
    s_add_u32 m0, s91, 2048
    s_nop 0
    buffer_load_dwordx4 v3, s[20:23], s72 offen lds
    s_waitcnt lgkmcnt(1)
    v_mfma_f32_16x16x32_bf16 v[176:179], v[192:195], v[216:219], v[176:179]
    v_mfma_f32_16x16x32_bf16 v[180:183], v[192:195], v[220:223], v[180:183]
    ds_read_b128 v[188:191], v198 offset:6400
    s_add_u32 m0, s91, 3072
    s_nop 0
    buffer_load_dwordx4 v4, s[20:23], s72 offen lds
    s_waitcnt lgkmcnt(1)
    v_mfma_f32_16x16x32_bf16 v[176:179], v[184:187], v[224:227], v[176:179]
    v_mfma_f32_16x16x32_bf16 v[180:183], v[184:187], v[228:231], v[180:183]
    ds_read_b128 v[192:195], v249 offset:6400
    v_cvt_pk_bf16_f32 v52, v168, v169
    v_cvt_pk_bf16_f32 v53, v170, v171
    v_cvt_pk_bf16_f32 v132, v172, v173
    v_cvt_pk_bf16_f32 v133, v174, v175
    s_add_u32 m0, s91, 4096
    s_nop 0
    buffer_load_dwordx4 v5, s[20:23], s72 offen lds
    s_waitcnt lgkmcnt(1)
    v_mfma_f32_16x16x32_bf16 v[176:179], v[188:191], v[232:235], v[176:179]
    v_mfma_f32_16x16x32_bf16 v[180:183], v[188:191], v[236:239], v[180:183]
    s_waitcnt vmcnt(11)
    ds_read_b128 v[184:187], v198 offset:12288
    s_add_u32 m0, s91, 5120
    s_nop 0
    buffer_load_dwordx4 v6, s[20:23], s72 offen lds
    s_waitcnt lgkmcnt(1)
    v_mfma_f32_16x16x32_bf16 v[176:179], v[192:195], v[240:243], v[176:179]
    v_mfma_f32_16x16x32_bf16 v[180:183], v[192:195], v[244:247], v[180:183]
    ds_read_b128 v[188:191], v249 offset:12288
    s_add_u32 s72, s81, 5160960
    s_add_u32 m0, s91, 6144
    s_nop 0
    buffer_load_dwordx4 v1, s[20:23], s72 offen lds
    s_waitcnt lgkmcnt(1)
    v_mfma_f32_16x16x32_bf16 v[168:171], v[184:187], v[200:203], 0
    v_mfma_f32_16x16x32_bf16 v[172:175], v[184:187], v[204:207], 0
    ds_read_b128 v[192:195], v198 offset:12416
    s_add_u32 m0, s91, 7168
    s_nop 0
    buffer_load_dwordx4 v2, s[20:23], s72 offen lds
    s_waitcnt lgkmcnt(1)
    v_mfma_f32_16x16x32_bf16 v[168:171], v[188:191], v[208:211], v[168:171]
    v_mfma_f32_16x16x32_bf16 v[172:175], v[188:191], v[212:215], v[172:175]
    ds_read_b128 v[184:187], v249 offset:12416
    s_add_u32 m0, s91, 8192
    s_nop 0
    buffer_load_dwordx4 v3, s[20:23], s72 offen lds
    s_waitcnt lgkmcnt(1)
    v_mfma_f32_16x16x32_bf16 v[168:171], v[192:195], v[216:219], v[168:171]
    v_mfma_f32_16x16x32_bf16 v[172:175], v[192:195], v[220:223], v[172:175]
    ds_read_b128 v[188:191], v198 offset:12544
    s_add_u32 m0, s91, 9216
    s_nop 0
    buffer_load_dwordx4 v4, s[20:23], s72 offen lds
    s_waitcnt lgkmcnt(1)
    v_mfma_f32_16x16x32_bf16 v[168:171], v[184:187], v[224:227], v[168:171]
    v_mfma_f32_16x16x32_bf16 v[172:175], v[184:187], v[228:231], v[172:175]
    ds_read_b128 v[192:195], v249 offset:12544
    v_cvt_pk_bf16_f32 v54, v176, v177
    v_cvt_pk_bf16_f32 v55, v178, v179
    v_cvt_pk_bf16_f32 v134, v180, v181
    v_cvt_pk_bf16_f32 v135, v182, v183
    s_add_u32 m0, s91, 10240
    s_nop 0
    buffer_load_dwordx4 v5, s[20:23], s72 offen lds
    s_waitcnt lgkmcnt(1)
    v_mfma_f32_16x16x32_bf16 v[168:171], v[188:191], v[232:235], v[168:171]
    v_mfma_f32_16x16x32_bf16 v[172:175], v[188:191], v[236:239], v[172:175]
    s_waitcnt vmcnt(11)
    ds_read_b128 v[184:187], v198 offset:18432
    s_add_u32 m0, s91, 11264
    s_nop 0
    buffer_load_dwordx4 v6, s[20:23], s72 offen lds
    s_waitcnt lgkmcnt(1)
    v_mfma_f32_16x16x32_bf16 v[168:171], v[192:195], v[240:243], v[168:171]
    v_mfma_f32_16x16x32_bf16 v[172:175], v[192:195], v[244:247], v[172:175]
    ds_read_b128 v[188:191], v249 offset:18432
    s_add_u32 s72, s81, 5505024
    s_add_u32 m0, s91, 12288
    s_nop 0
    buffer_load_dwordx4 v1, s[20:23], s72 offen lds
    s_waitcnt lgkmcnt(1)
    v_mfma_f32_16x16x32_bf16 v[176:179], v[184:187], v[200:203], 0
    v_mfma_f32_16x16x32_bf16 v[180:183], v[184:187], v[204:207], 0
    ds_read_b128 v[192:195], v198 offset:18560
    s_add_u32 m0, s91, 13312
    s_nop 0
    buffer_load_dwordx4 v2, s[20:23], s72 offen lds
    s_waitcnt lgkmcnt(1)
    v_mfma_f32_16x16x32_bf16 v[176:179], v[188:191], v[208:211], v[176:179]
    v_mfma_f32_16x16x32_bf16 v[180:183], v[188:191], v[212:215], v[180:183]
    ds_read_b128 v[184:187], v249 offset:18560
    s_add_u32 m0, s91, 14336
    s_nop 0
    buffer_load_dwordx4 v3, s[20:23], s72 offen lds
    s_waitcnt lgkmcnt(1)
    v_mfma_f32_16x16x32_bf16 v[176:179], v[192:195], v[216:219], v[176:179]
    v_mfma_f32_16x16x32_bf16 v[180:183], v[192:195], v[220:223], v[180:183]
    ds_read_b128 v[188:191], v198 offset:18688
    s_add_u32 m0, s91, 15360
    s_nop 0
    buffer_load_dwordx4 v4, s[20:23], s72 offen lds
    s_waitcnt lgkmcnt(1)
    v_mfma_f32_16x16x32_bf16 v[176:179], v[184:187], v[224:227], v[176:179]
    v_mfma_f32_16x16x32_bf16 v[180:183], v[184:187], v[228:231], v[180:183]
    ds_read_b128 v[192:195], v249 offset:18688
    v_cvt_pk_bf16_f32 v56, v168, v169
    v_cvt_pk_bf16_f32 v57, v170, v171
    v_cvt_pk_bf16_f32 v136, v172, v173
    v_cvt_pk_bf16_f32 v137, v174, v175
    s_add_u32 m0, s91, 16384
    s_nop 0
    buffer_load_dwordx4 v5, s[20:23], s72 offen lds
    s_waitcnt lgkmcnt(1)
    v_mfma_f32_16x16x32_bf16 v[176:179], v[188:191], v[232:235], v[176:179]
    v_mfma_f32_16x16x32_bf16 v[180:183], v[188:191], v[236:239], v[180:183]
    s_waitcnt vmcnt(11)
    ds_read_b128 v[184:187], v198 offset:0
    s_add_u32 m0, s91, 17408
    s_nop 0
    buffer_load_dwordx4 v6, s[20:23], s72 offen lds
    s_waitcnt lgkmcnt(1)
    v_mfma_f32_16x16x32_bf16 v[176:179], v[192:195], v[240:243], v[176:179]
    v_mfma_f32_16x16x32_bf16 v[180:183], v[192:195], v[244:247], v[180:183]
    ds_read_b128 v[188:191], v249 offset:0
    s_add_u32 s72, s81, 5554176
    s_add_u32 m0, s91, 18432
    s_nop 0
    buffer_load_dwordx4 v1, s[20:23], s72 offen lds
    s_waitcnt lgkmcnt(1)
    v_mfma_f32_16x16x32_bf16 v[168:171], v[184:187], v[200:203], 0
    v_mfma_f32_16x16x32_bf16 v[172:175], v[184:187], v[204:207], 0
    ds_read_b128 v[192:195], v198 offset:128
    s_add_u32 m0, s91, 19456
    s_nop 0
    buffer_load_dwordx4 v2, s[20:23], s72 offen lds
    s_waitcnt lgkmcnt(1)
    v_mfma_f32_16x16x32_bf16 v[168:171], v[188:191], v[208:211], v[168:171]
    v_mfma_f32_16x16x32_bf16 v[172:175], v[188:191], v[212:215], v[172:175]
    ds_read_b128 v[184:187], v249 offset:128
    s_add_u32 m0, s91, 20480
    s_nop 0
    buffer_load_dwordx4 v3, s[20:23], s72 offen lds
    s_waitcnt lgkmcnt(1)
    v_mfma_f32_16x16x32_bf16 v[168:171], v[192:195], v[216:219], v[168:171]
    v_mfma_f32_16x16x32_bf16 v[172:175], v[192:195], v[220:223], v[172:175]
    ds_read_b128 v[188:191], v198 offset:256
    s_add_u32 m0, s91, 21504
    s_nop 0
    buffer_load_dwordx4 v4, s[20:23], s72 offen lds
    s_waitcnt lgkmcnt(1)
    v_mfma_f32_16x16x32_bf16 v[168:171], v[184:187], v[224:227], v[168:171]
    v_mfma_f32_16x16x32_bf16 v[172:175], v[184:187], v[228:231], v[172:175]
    ds_read_b128 v[192:195], v249 offset:256
    v_cvt_pk_bf16_f32 v58, v176, v177
    v_cvt_pk_bf16_f32 v59, v178, v179
    v_cvt_pk_bf16_f32 v138, v180, v181
    v_cvt_pk_bf16_f32 v139, v182, v183
    s_add_u32 m0, s91, 22528
    s_nop 0
    buffer_load_dwordx4 v5, s[20:23], s72 offen lds
    s_waitcnt lgkmcnt(1)
    v_mfma_f32_16x16x32_bf16 v[168:171], v[188:191], v[232:235], v[168:171]
    v_mfma_f32_16x16x32_bf16 v[172:175], v[188:191], v[236:239], v[172:175]
    s_waitcnt vmcnt(11)
    ds_read_b128 v[184:187], v198 offset:6144
    s_add_u32 m0, s91, 23552
    s_nop 0
    buffer_load_dwordx4 v6, s[20:23], s72 offen lds
    s_waitcnt lgkmcnt(1)
    v_mfma_f32_16x16x32_bf16 v[168:171], v[192:195], v[240:243], v[168:171]
    v_mfma_f32_16x16x32_bf16 v[172:175], v[192:195], v[244:247], v[172:175]
    ds_read_b128 v[188:191], v249 offset:6144
    s_add_u32 s72, s81, 5898240
    s_add_u32 m0, s91, 0
    s_nop 0
    buffer_load_dwordx4 v1, s[20:23], s72 offen lds
    s_waitcnt lgkmcnt(1)
    v_mfma_f32_16x16x32_bf16 v[176:179], v[184:187], v[200:203], 0
    v_mfma_f32_16x16x32_bf16 v[180:183], v[184:187], v[204:207], 0
    ds_read_b128 v[192:195], v198 offset:6272
    s_add_u32 m0, s91, 1024
    s_nop 0
    buffer_load_dwordx4 v2, s[20:23], s72 offen lds
    s_waitcnt lgkmcnt(1)
    v_mfma_f32_16x16x32_bf16 v[176:179], v[188:191], v[208:211], v[176:179]
    v_mfma_f32_16x16x32_bf16 v[180:183], v[188:191], v[212:215], v[180:183]
    ds_read_b128 v[184:187], v249 offset:6272
    s_add_u32 m0, s91, 2048
    s_nop 0
    buffer_load_dwordx4 v3, s[20:23], s72 offen lds
    s_waitcnt lgkmcnt(1)
    v_mfma_f32_16x16x32_bf16 v[176:179], v[192:195], v[216:219], v[176:179]
    v_mfma_f32_16x16x32_bf16 v[180:183], v[192:195], v[220:223], v[180:183]
    ds_read_b128 v[188:191], v198 offset:6400
    s_add_u32 m0, s91, 3072
    s_nop 0
    buffer_load_dwordx4 v4, s[20:23], s72 offen lds
    s_waitcnt lgkmcnt(1)
    v_mfma_f32_16x16x32_bf16 v[176:179], v[184:187], v[224:227], v[176:179]
    v_mfma_f32_16x16x32_bf16 v[180:183], v[184:187], v[228:231], v[180:183]
    ds_read_b128 v[192:195], v249 offset:6400
    v_cvt_pk_bf16_f32 v60, v168, v169
    v_cvt_pk_bf16_f32 v61, v170, v171
    v_cvt_pk_bf16_f32 v140, v172, v173
    v_cvt_pk_bf16_f32 v141, v174, v175
    s_add_u32 m0, s91, 4096
    s_nop 0
    buffer_load_dwordx4 v5, s[20:23], s72 offen lds
    s_waitcnt lgkmcnt(1)
    v_mfma_f32_16x16x32_bf16 v[176:179], v[188:191], v[232:235], v[176:179]
    v_mfma_f32_16x16x32_bf16 v[180:183], v[188:191], v[236:239], v[180:183]
    s_waitcnt vmcnt(11)
    ds_read_b128 v[184:187], v198 offset:12288
    s_add_u32 m0, s91, 5120
    s_nop 0
    buffer_load_dwordx4 v6, s[20:23], s72 offen lds
    s_waitcnt lgkmcnt(1)
    v_mfma_f32_16x16x32_bf16 v[176:179], v[192:195], v[240:243], v[176:179]
    v_mfma_f32_16x16x32_bf16 v[180:183], v[192:195], v[244:247], v[180:183]
    ds_read_b128 v[188:191], v249 offset:12288
    s_add_u32 s72, s81, 5947392
    s_add_u32 m0, s91, 6144
    s_nop 0
    buffer_load_dwordx4 v1, s[20:23], s72 offen lds
    s_waitcnt lgkmcnt(1)
    v_mfma_f32_16x16x32_bf16 v[168:171], v[184:187], v[200:203], 0
    v_mfma_f32_16x16x32_bf16 v[172:175], v[184:187], v[204:207], 0
    ds_read_b128 v[192:195], v198 offset:12416
    s_add_u32 m0, s91, 7168
    s_nop 0
    buffer_load_dwordx4 v2, s[20:23], s72 offen lds
    s_waitcnt lgkmcnt(1)
    v_mfma_f32_16x16x32_bf16 v[168:171], v[188:191], v[208:211], v[168:171]
    v_mfma_f32_16x16x32_bf16 v[172:175], v[188:191], v[212:215], v[172:175]
    ds_read_b128 v[184:187], v249 offset:12416
    s_add_u32 m0, s91, 8192
    s_nop 0
    buffer_load_dwordx4 v3, s[20:23], s72 offen lds
    s_waitcnt lgkmcnt(1)
    v_mfma_f32_16x16x32_bf16 v[168:171], v[192:195], v[216:219], v[168:171]
    v_mfma_f32_16x16x32_bf16 v[172:175], v[192:195], v[220:223], v[172:175]
    ds_read_b128 v[188:191], v198 offset:12544
    s_add_u32 m0, s91, 9216
    s_nop 0
    buffer_load_dwordx4 v4, s[20:23], s72 offen lds
    s_waitcnt lgkmcnt(1)
    v_mfma_f32_16x16x32_bf16 v[168:171], v[184:187], v[224:227], v[168:171]
    v_mfma_f32_16x16x32_bf16 v[172:175], v[184:187], v[228:231], v[172:175]
    ds_read_b128 v[192:195], v249 offset:12544
    v_cvt_pk_bf16_f32 v62, v176, v177
    v_cvt_pk_bf16_f32 v63, v178, v179
    v_cvt_pk_bf16_f32 v142, v180, v181
    v_cvt_pk_bf16_f32 v143, v182, v183
    s_add_u32 m0, s91, 10240
    s_nop 0
    buffer_load_dwordx4 v5, s[20:23], s72 offen lds
    s_waitcnt lgkmcnt(1)
    v_mfma_f32_16x16x32_bf16 v[168:171], v[188:191], v[232:235], v[168:171]
    v_mfma_f32_16x16x32_bf16 v[172:175], v[188:191], v[236:239], v[172:175]
    s_waitcnt vmcnt(11)
    ds_read_b128 v[184:187], v198 offset:18432
    s_add_u32 m0, s91, 11264
    s_nop 0
    buffer_load_dwordx4 v6, s[20:23], s72 offen lds
    s_waitcnt lgkmcnt(1)
    v_mfma_f32_16x16x32_bf16 v[168:171], v[192:195], v[240:243], v[168:171]
    v_mfma_f32_16x16x32_bf16 v[172:175], v[192:195], v[244:247], v[172:175]
    ds_read_b128 v[188:191], v249 offset:18432
    s_add_u32 s72, s81, 6291456
    s_add_u32 m0, s91, 12288
    s_nop 0
    buffer_load_dwordx4 v1, s[20:23], s72 offen lds
    s_waitcnt lgkmcnt(1)
    v_mfma_f32_16x16x32_bf16 v[176:179], v[184:187], v[200:203], 0
    v_mfma_f32_16x16x32_bf16 v[180:183], v[184:187], v[204:207], 0
    ds_read_b128 v[192:195], v198 offset:18560
    s_add_u32 m0, s91, 13312
    s_nop 0
    buffer_load_dwordx4 v2, s[20:23], s72 offen lds
    s_waitcnt lgkmcnt(1)
    v_mfma_f32_16x16x32_bf16 v[176:179], v[188:191], v[208:211], v[176:179]
    v_mfma_f32_16x16x32_bf16 v[180:183], v[188:191], v[212:215], v[180:183]
    ds_read_b128 v[184:187], v249 offset:18560
    s_add_u32 m0, s91, 14336
    s_nop 0
    buffer_load_dwordx4 v3, s[20:23], s72 offen lds
    s_waitcnt lgkmcnt(1)
    v_mfma_f32_16x16x32_bf16 v[176:179], v[192:195], v[216:219], v[176:179]
    v_mfma_f32_16x16x32_bf16 v[180:183], v[192:195], v[220:223], v[180:183]
    ds_read_b128 v[188:191], v198 offset:18688
    s_add_u32 m0, s91, 15360
    s_nop 0
    buffer_load_dwordx4 v4, s[20:23], s72 offen lds
    s_waitcnt lgkmcnt(1)
    v_mfma_f32_16x16x32_bf16 v[176:179], v[184:187], v[224:227], v[176:179]
    v_mfma_f32_16x16x32_bf16 v[180:183], v[184:187], v[228:231], v[180:183]
    ds_read_b128 v[192:195], v249 offset:18688
    v_cvt_pk_bf16_f32 v64, v168, v169
    v_cvt_pk_bf16_f32 v65, v170, v171
    v_cvt_pk_bf16_f32 v144, v172, v173
    v_cvt_pk_bf16_f32 v145, v174, v175
    s_add_u32 m0, s91, 16384
    s_nop 0
    buffer_load_dwordx4 v5, s[20:23], s72 offen lds
    s_waitcnt lgkmcnt(1)
    v_mfma_f32_16x16x32_bf16 v[176:179], v[188:191], v[232:235], v[176:179]
    v_mfma_f32_16x16x32_bf16 v[180:183], v[188:191], v[236:239], v[180:183]
    s_waitcnt vmcnt(11)
    ds_read_b128 v[184:187], v198 offset:0
    s_add_u32 m0, s91, 17408
    s_nop 0
    buffer_load_dwordx4 v6, s[20:23], s72 offen lds
    s_waitcnt lgkmcnt(1)
    v_mfma_f32_16x16x32_bf16 v[176:179], v[192:195], v[240:243], v[176:179]
    v_mfma_f32_16x16x32_bf16 v[180:183], v[192:195], v[244:247], v[180:183]
    ds_read_b128 v[188:191], v249 offset:0
    s_add_u32 s72, s81, 6340608
    s_add_u32 m0, s91, 18432
    s_nop 0
    buffer_load_dwordx4 v1, s[20:23], s72 offen lds
    s_waitcnt lgkmcnt(1)
    v_mfma_f32_16x16x32_bf16 v[168:171], v[184:187], v[200:203], 0
    v_mfma_f32_16x16x32_bf16 v[172:175], v[184:187], v[204:207], 0
    ds_read_b128 v[192:195], v198 offset:128
    s_add_u32 m0, s91, 19456
    s_nop 0
    buffer_load_dwordx4 v2, s[20:23], s72 offen lds
    s_waitcnt lgkmcnt(1)
    v_mfma_f32_16x16x32_bf16 v[168:171], v[188:191], v[208:211], v[168:171]
    v_mfma_f32_16x16x32_bf16 v[172:175], v[188:191], v[212:215], v[172:175]
    ds_read_b128 v[184:187], v249 offset:128
    s_add_u32 m0, s91, 20480
    s_nop 0
    buffer_load_dwordx4 v3, s[20:23], s72 offen lds
    s_waitcnt lgkmcnt(1)
    v_mfma_f32_16x16x32_bf16 v[168:171], v[192:195], v[216:219], v[168:171]
    v_mfma_f32_16x16x32_bf16 v[172:175], v[192:195], v[220:223], v[172:175]
    ds_read_b128 v[188:191], v198 offset:256
    s_add_u32 m0, s91, 21504
    s_nop 0
    buffer_load_dwordx4 v4, s[20:23], s72 offen lds
    s_waitcnt lgkmcnt(1)
    v_mfma_f32_16x16x32_bf16 v[168:171], v[184:187], v[224:227], v[168:171]
    v_mfma_f32_16x16x32_bf16 v[172:175], v[184:187], v[228:231], v[172:175]
    ds_read_b128 v[192:195], v249 offset:256
    v_cvt_pk_bf16_f32 v66, v176, v177
    v_cvt_pk_bf16_f32 v67, v178, v179
    v_cvt_pk_bf16_f32 v146, v180, v181
    v_cvt_pk_bf16_f32 v147, v182, v183
    s_add_u32 m0, s91, 22528
    s_nop 0
    buffer_load_dwordx4 v5, s[20:23], s72 offen lds
    s_waitcnt lgkmcnt(1)
    v_mfma_f32_16x16x32_bf16 v[168:171], v[188:191], v[232:235], v[168:171]
    v_mfma_f32_16x16x32_bf16 v[172:175], v[188:191], v[236:239], v[172:175]
    s_waitcnt vmcnt(11)
    ds_read_b128 v[184:187], v198 offset:6144
    s_add_u32 m0, s91, 23552
    s_nop 0
    buffer_load_dwordx4 v6, s[20:23], s72 offen lds
    s_waitcnt lgkmcnt(1)
    v_mfma_f32_16x16x32_bf16 v[168:171], v[192:195], v[240:243], v[168:171]
    v_mfma_f32_16x16x32_bf16 v[172:175], v[192:195], v[244:247], v[172:175]
    ds_read_b128 v[188:191], v249 offset:6144
    s_add_u32 s72, s81, 6684672
    s_add_u32 m0, s91, 0
    s_nop 0
    buffer_load_dwordx4 v1, s[20:23], s72 offen lds
    s_waitcnt lgkmcnt(1)
    v_mfma_f32_16x16x32_bf16 v[176:179], v[184:187], v[200:203], 0
    v_mfma_f32_16x16x32_bf16 v[180:183], v[184:187], v[204:207], 0
    ds_read_b128 v[192:195], v198 offset:6272
    s_add_u32 m0, s91, 1024
    s_nop 0
    buffer_load_dwordx4 v2, s[20:23], s72 offen lds
    s_waitcnt lgkmcnt(1)
    v_mfma_f32_16x16x32_bf16 v[176:179], v[188:191], v[208:211], v[176:179]
    v_mfma_f32_16x16x32_bf16 v[180:183], v[188:191], v[212:215], v[180:183]
    ds_read_b128 v[184:187], v249 offset:6272
    s_add_u32 m0, s91, 2048
    s_nop 0
    buffer_load_dwordx4 v3, s[20:23], s72 offen lds
    s_waitcnt lgkmcnt(1)
    v_mfma_f32_16x16x32_bf16 v[176:179], v[192:195], v[216:219], v[176:179]
    v_mfma_f32_16x16x32_bf16 v[180:183], v[192:195], v[220:223], v[180:183]
    ds_read_b128 v[188:191], v198 offset:6400
    s_add_u32 m0, s91, 3072
    s_nop 0
    buffer_load_dwordx4 v4, s[20:23], s72 offen lds
    s_waitcnt lgkmcnt(1)
    v_mfma_f32_16x16x32_bf16 v[176:179], v[184:187], v[224:227], v[176:179]
    v_mfma_f32_16x16x32_bf16 v[180:183], v[184:187], v[228:231], v[180:183]
    ds_read_b128 v[192:195], v249 offset:6400
    v_cvt_pk_bf16_f32 v68, v168, v169
    v_cvt_pk_bf16_f32 v69, v170, v171
    v_cvt_pk_bf16_f32 v148, v172, v173
    v_cvt_pk_bf16_f32 v149, v174, v175
    s_add_u32 m0, s91, 4096
    s_nop 0
    buffer_load_dwordx4 v5, s[20:23], s72 offen lds
    s_waitcnt lgkmcnt(1)
    v_mfma_f32_16x16x32_bf16 v[176:179], v[188:191], v[232:235], v[176:179]
    v_mfma_f32_16x16x32_bf16 v[180:183], v[188:191], v[236:239], v[180:183]
    s_waitcnt vmcnt(11)
    ds_read_b128 v[184:187], v198 offset:12288
    s_add_u32 m0, s91, 5120
    s_nop 0
    buffer_load_dwordx4 v6, s[20:23], s72 offen lds
    s_waitcnt lgkmcnt(1)
    v_mfma_f32_16x16x32_bf16 v[176:179], v[192:195], v[240:243], v[176:179]
    v_mfma_f32_16x16x32_bf16 v[180:183], v[192:195], v[244:247], v[180:183]
    ds_read_b128 v[188:191], v249 offset:12288
    s_add_u32 s72, s81, 6733824
    s_add_u32 m0, s91, 6144
    s_nop 0
    buffer_load_dwordx4 v1, s[20:23], s72 offen lds
    s_waitcnt lgkmcnt(1)
    v_mfma_f32_16x16x32_bf16 v[168:171], v[184:187], v[200:203], 0
    v_mfma_f32_16x16x32_bf16 v[172:175], v[184:187], v[204:207], 0
    ds_read_b128 v[192:195], v198 offset:12416
    s_add_u32 m0, s91, 7168
    s_nop 0
    buffer_load_dwordx4 v2, s[20:23], s72 offen lds
    s_waitcnt lgkmcnt(1)
    v_mfma_f32_16x16x32_bf16 v[168:171], v[188:191], v[208:211], v[168:171]
    v_mfma_f32_16x16x32_bf16 v[172:175], v[188:191], v[212:215], v[172:175]
    ds_read_b128 v[184:187], v249 offset:12416
    s_add_u32 m0, s91, 8192
    s_nop 0
    buffer_load_dwordx4 v3, s[20:23], s72 offen lds
    s_waitcnt lgkmcnt(1)
    v_mfma_f32_16x16x32_bf16 v[168:171], v[192:195], v[216:219], v[168:171]
    v_mfma_f32_16x16x32_bf16 v[172:175], v[192:195], v[220:223], v[172:175]
    ds_read_b128 v[188:191], v198 offset:12544
    s_add_u32 m0, s91, 9216
    s_nop 0
    buffer_load_dwordx4 v4, s[20:23], s72 offen lds
    s_waitcnt lgkmcnt(1)
    v_mfma_f32_16x16x32_bf16 v[168:171], v[184:187], v[224:227], v[168:171]
    v_mfma_f32_16x16x32_bf16 v[172:175], v[184:187], v[228:231], v[172:175]
    ds_read_b128 v[192:195], v249 offset:12544
    v_cvt_pk_bf16_f32 v70, v176, v177
    v_cvt_pk_bf16_f32 v71, v178, v179
    v_cvt_pk_bf16_f32 v150, v180, v181
    v_cvt_pk_bf16_f32 v151, v182, v183
    s_add_u32 m0, s91, 10240
    s_nop 0
    buffer_load_dwordx4 v5, s[20:23], s72 offen lds
    s_waitcnt lgkmcnt(1)
    v_mfma_f32_16x16x32_bf16 v[168:171], v[188:191], v[232:235], v[168:171]
    v_mfma_f32_16x16x32_bf16 v[172:175], v[188:191], v[236:239], v[172:175]
    s_waitcnt vmcnt(11)
    ds_read_b128 v[184:187], v198 offset:18432
    s_add_u32 m0, s91, 11264
    s_nop 0
    buffer_load_dwordx4 v6, s[20:23], s72 offen lds
    s_waitcnt lgkmcnt(1)
    v_mfma_f32_16x16x32_bf16 v[168:171], v[192:195], v[240:243], v[168:171]
    v_mfma_f32_16x16x32_bf16 v[172:175], v[192:195], v[244:247], v[172:175]
    ds_read_b128 v[188:191], v249 offset:18432
    s_add_u32 s72, s81, 7077888
    s_add_u32 m0, s91, 12288
    s_nop 0
    buffer_load_dwordx4 v1, s[20:23], s72 offen lds
    s_waitcnt lgkmcnt(1)
    v_mfma_f32_16x16x32_bf16 v[176:179], v[184:187], v[200:203], 0
    v_mfma_f32_16x16x32_bf16 v[180:183], v[184:187], v[204:207], 0
    ds_read_b128 v[192:195], v198 offset:18560
    s_add_u32 m0, s91, 13312
    s_nop 0
    buffer_load_dwordx4 v2, s[20:23], s72 offen lds
    s_waitcnt lgkmcnt(1)
    v_mfma_f32_16x16x32_bf16 v[176:179], v[188:191], v[208:211], v[176:179]
    v_mfma_f32_16x16x32_bf16 v[180:183], v[188:191], v[212:215], v[180:183]
    ds_read_b128 v[184:187], v249 offset:18560
    s_add_u32 m0, s91, 14336
    s_nop 0
    buffer_load_dwordx4 v3, s[20:23], s72 offen lds
    s_waitcnt lgkmcnt(1)
    v_mfma_f32_16x16x32_bf16 v[176:179], v[192:195], v[216:219], v[176:179]
    v_mfma_f32_16x16x32_bf16 v[180:183], v[192:195], v[220:223], v[180:183]
    ds_read_b128 v[188:191], v198 offset:18688
    s_add_u32 m0, s91, 15360
    s_nop 0
    buffer_load_dwordx4 v4, s[20:23], s72 offen lds
    s_waitcnt lgkmcnt(1)
    v_mfma_f32_16x16x32_bf16 v[176:179], v[184:187], v[224:227], v[176:179]
    v_mfma_f32_16x16x32_bf16 v[180:183], v[184:187], v[228:231], v[180:183]
    ds_read_b128 v[192:195], v249 offset:18688
    v_cvt_pk_bf16_f32 v72, v168, v169
    v_cvt_pk_bf16_f32 v73, v170, v171
    v_cvt_pk_bf16_f32 v152, v172, v173
    v_cvt_pk_bf16_f32 v153, v174, v175
    s_add_u32 m0, s91, 16384
    s_nop 0
    buffer_load_dwordx4 v5, s[20:23], s72 offen lds
    s_waitcnt lgkmcnt(1)
    v_mfma_f32_16x16x32_bf16 v[176:179], v[188:191], v[232:235], v[176:179]
    v_mfma_f32_16x16x32_bf16 v[180:183], v[188:191], v[236:239], v[180:183]
    s_waitcnt vmcnt(11)
    ds_read_b128 v[184:187], v198 offset:0
    s_add_u32 m0, s91, 17408
    s_nop 0
    buffer_load_dwordx4 v6, s[20:23], s72 offen lds
    s_waitcnt lgkmcnt(1)
    v_mfma_f32_16x16x32_bf16 v[176:179], v[192:195], v[240:243], v[176:179]
    v_mfma_f32_16x16x32_bf16 v[180:183], v[192:195], v[244:247], v[180:183]
    ds_read_b128 v[188:191], v249 offset:0
    s_add_u32 s72, s81, 7127040
    s_add_u32 m0, s91, 18432
    s_nop 0
    buffer_load_dwordx4 v1, s[20:23], s72 offen lds
    s_waitcnt lgkmcnt(1)
    v_mfma_f32_16x16x32_bf16 v[168:171], v[184:187], v[200:203], 0
    v_mfma_f32_16x16x32_bf16 v[172:175], v[184:187], v[204:207], 0
    ds_read_b128 v[192:195], v198 offset:128
    s_add_u32 m0, s91, 19456
    s_nop 0
    buffer_load_dwordx4 v2, s[20:23], s72 offen lds
    s_waitcnt lgkmcnt(1)
    v_mfma_f32_16x16x32_bf16 v[168:171], v[188:191], v[208:211], v[168:171]
    v_mfma_f32_16x16x32_bf16 v[172:175], v[188:191], v[212:215], v[172:175]
    ds_read_b128 v[184:187], v249 offset:128
    s_add_u32 m0, s91, 20480
    s_nop 0
    buffer_load_dwordx4 v3, s[20:23], s72 offen lds
    s_waitcnt lgkmcnt(1)
    v_mfma_f32_16x16x32_bf16 v[168:171], v[192:195], v[216:219], v[168:171]
    v_mfma_f32_16x16x32_bf16 v[172:175], v[192:195], v[220:223], v[172:175]
    ds_read_b128 v[188:191], v198 offset:256
    s_add_u32 m0, s91, 21504
    s_nop 0
    buffer_load_dwordx4 v4, s[20:23], s72 offen lds
    s_waitcnt lgkmcnt(1)
    v_mfma_f32_16x16x32_bf16 v[168:171], v[184:187], v[224:227], v[168:171]
    v_mfma_f32_16x16x32_bf16 v[172:175], v[184:187], v[228:231], v[172:175]
    ds_read_b128 v[192:195], v249 offset:256
    v_cvt_pk_bf16_f32 v74, v176, v177
    v_cvt_pk_bf16_f32 v75, v178, v179
    v_cvt_pk_bf16_f32 v154, v180, v181
    v_cvt_pk_bf16_f32 v155, v182, v183
    s_add_u32 m0, s91, 22528
    s_nop 0
    buffer_load_dwordx4 v5, s[20:23], s72 offen lds
    s_waitcnt lgkmcnt(1)
    v_mfma_f32_16x16x32_bf16 v[168:171], v[188:191], v[232:235], v[168:171]
    v_mfma_f32_16x16x32_bf16 v[172:175], v[188:191], v[236:239], v[172:175]
    s_waitcnt vmcnt(11)
    ds_read_b128 v[184:187], v198 offset:6144
    v_mov_b32 v7, 163632
    ds_write_b32 v7, v7
    s_waitcnt lgkmcnt(0)
    s_add_u32 m0, s91, 23552
    s_nop 0
    buffer_load_dwordx4 v6, s[20:23], s72 offen lds
    s_waitcnt lgkmcnt(1)
    v_mfma_f32_16x16x32_bf16 v[168:171], v[192:195], v[240:243], v[168:171]
    v_mfma_f32_16x16x32_bf16 v[172:175], v[192:195], v[244:247], v[172:175]
    ds_read_b128 v[188:191], v249 offset:6144
    s_add_u32 s72, s81, 7471104
    s_add_u32 m0, s91, 0
    s_nop 0
    buffer_load_dwordx4 v1, s[20:23], s72 offen lds
    s_waitcnt lgkmcnt(1)
    v_mfma_f32_16x16x32_bf16 v[176:179], v[184:187], v[200:203], 0
    v_mfma_f32_16x16x32_bf16 v[180:183], v[184:187], v[204:207], 0
    ds_read_b128 v[192:195], v198 offset:6272
    s_add_u32 m0, s91, 1024
    s_nop 0
    buffer_load_dwordx4 v2, s[20:23], s72 offen lds
    s_waitcnt lgkmcnt(1)
    v_mfma_f32_16x16x32_bf16 v[176:179], v[188:191], v[208:211], v[176:179]
    v_mfma_f32_16x16x32_bf16 v[180:183], v[188:191], v[212:215], v[180:183]
    ds_read_b128 v[184:187], v249 offset:6272
    s_add_u32 m0, s91, 2048
    s_nop 0
    buffer_load_dwordx4 v3, s[20:23], s72 offen lds
    s_waitcnt lgkmcnt(1)
    v_mfma_f32_16x16x32_bf16 v[176:179], v[192:195], v[216:219], v[176:179]
    v_mfma_f32_16x16x32_bf16 v[180:183], v[192:195], v[220:223], v[180:183]
    ds_read_b128 v[188:191], v198 offset:6400
    s_add_u32 m0, s91, 3072
    s_nop 0
    buffer_load_dwordx4 v4, s[20:23], s72 offen lds
    s_waitcnt lgkmcnt(1)
    v_mfma_f32_16x16x32_bf16 v[176:179], v[184:187], v[224:227], v[176:179]
    v_mfma_f32_16x16x32_bf16 v[180:183], v[184:187], v[228:231], v[180:183]
    ds_read_b128 v[192:195], v249 offset:6400
    v_cvt_pk_bf16_f32 v76, v168, v169
    v_cvt_pk_bf16_f32 v77, v170, v171
    v_cvt_pk_bf16_f32 v156, v172, v173
    v_cvt_pk_bf16_f32 v157, v174, v175
    s_add_u32 m0, s91, 4096
    s_nop 0
    buffer_load_dwordx4 v5, s[20:23], s72 offen lds
    s_waitcnt lgkmcnt(1)
    v_mfma_f32_16x16x32_bf16 v[176:179], v[188:191], v[232:235], v[176:179]
    v_mfma_f32_16x16x32_bf16 v[180:183], v[188:191], v[236:239], v[180:183]
    s_waitcnt vmcnt(11)
    ds_read_b128 v[184:187], v198 offset:12288
    s_add_u32 m0, s91, 5120
    s_nop 0
    buffer_load_dwordx4 v6, s[20:23], s72 offen lds
    s_waitcnt lgkmcnt(1)
    v_mfma_f32_16x16x32_bf16 v[176:179], v[192:195], v[240:243], v[176:179]
    v_mfma_f32_16x16x32_bf16 v[180:183], v[192:195], v[244:247], v[180:183]
    ds_read_b128 v[188:191], v249 offset:12288
    s_add_u32 s72, s81, 7520256
    s_add_u32 m0, s91, 6144
    s_nop 0
    buffer_load_dwordx4 v1, s[20:23], s72 offen lds
    s_waitcnt lgkmcnt(1)
    v_mfma_f32_16x16x32_bf16 v[168:171], v[184:187], v[200:203], 0
    v_mfma_f32_16x16x32_bf16 v[172:175], v[184:187], v[204:207], 0
    ds_read_b128 v[192:195], v198 offset:12416
    s_add_u32 m0, s91, 7168
    s_nop 0
    buffer_load_dwordx4 v2, s[20:23], s72 offen lds
    s_waitcnt lgkmcnt(1)
    v_mfma_f32_16x16x32_bf16 v[168:171], v[188:191], v[208:211], v[168:171]
    v_mfma_f32_16x16x32_bf16 v[172:175], v[188:191], v[212:215], v[172:175]
    ds_read_b128 v[184:187], v249 offset:12416
    s_add_u32 m0, s91, 8192
    s_nop 0
    buffer_load_dwordx4 v3, s[20:23], s72 offen lds
    s_waitcnt lgkmcnt(1)
    v_mfma_f32_16x16x32_bf16 v[168:171], v[192:195], v[216:219], v[168:171]
    v_mfma_f32_16x16x32_bf16 v[172:175], v[192:195], v[220:223], v[172:175]
    ds_read_b128 v[188:191], v198 offset:12544
    s_add_u32 m0, s91, 9216
    s_nop 0
    buffer_load_dwordx4 v4, s[20:23], s72 offen lds
    s_waitcnt lgkmcnt(1)
    v_mfma_f32_16x16x32_bf16 v[168:171], v[184:187], v[224:227], v[168:171]
    v_mfma_f32_16x16x32_bf16 v[172:175], v[184:187], v[228:231], v[172:175]
    ds_read_b128 v[192:195], v249 offset:12544
    v_cvt_pk_bf16_f32 v78, v176, v177
    v_cvt_pk_bf16_f32 v79, v178, v179
    v_cvt_pk_bf16_f32 v158, v180, v181
    v_cvt_pk_bf16_f32 v159, v182, v183
    s_add_u32 m0, s91, 10240
    s_nop 0
    buffer_load_dwordx4 v5, s[20:23], s72 offen lds
    s_waitcnt lgkmcnt(1)
    v_mfma_f32_16x16x32_bf16 v[168:171], v[188:191], v[232:235], v[168:171]
    v_mfma_f32_16x16x32_bf16 v[172:175], v[188:191], v[236:239], v[172:175]
    s_waitcnt vmcnt(11)
    ds_read_b128 v[184:187], v198 offset:18432
    s_add_u32 m0, s91, 11264
    s_nop 0
    buffer_load_dwordx4 v6, s[20:23], s72 offen lds
    s_waitcnt lgkmcnt(1)
    v_mfma_f32_16x16x32_bf16 v[168:171], v[192:195], v[240:243], v[168:171]
    v_mfma_f32_16x16x32_bf16 v[172:175], v[192:195], v[244:247], v[172:175]
    ds_read_b128 v[188:191], v249 offset:18432
    s_waitcnt lgkmcnt(1)
    v_mfma_f32_16x16x32_bf16 v[176:179], v[184:187], v[200:203], 0
    v_mfma_f32_16x16x32_bf16 v[180:183], v[184:187], v[204:207], 0
    ds_read_b128 v[192:195], v198 offset:18560
    s_waitcnt lgkmcnt(1)
    v_mfma_f32_16x16x32_bf16 v[176:179], v[188:191], v[208:211], v[176:179]
    v_mfma_f32_16x16x32_bf16 v[180:183], v[188:191], v[212:215], v[180:183]
    ds_read_b128 v[184:187], v249 offset:18560
    s_waitcnt lgkmcnt(1)
    v_mfma_f32_16x16x32_bf16 v[176:179], v[192:195], v[216:219], v[176:179]
    v_mfma_f32_16x16x32_bf16 v[180:183], v[192:195], v[220:223], v[180:183]
    ds_read_b128 v[188:191], v198 offset:18688
    s_waitcnt lgkmcnt(1)
    v_mfma_f32_16x16x32_bf16 v[176:179], v[184:187], v[224:227], v[176:179]
    v_mfma_f32_16x16x32_bf16 v[180:183], v[184:187], v[228:231], v[180:183]
    ds_read_b128 v[192:195], v249 offset:18688
    v_cvt_pk_bf16_f32 v80, v168, v169
    v_cvt_pk_bf16_f32 v81, v170, v171
    v_cvt_pk_bf16_f32 v160, v172, v173
    v_cvt_pk_bf16_f32 v161, v174, v175
    s_waitcnt lgkmcnt(1)
    v_mfma_f32_16x16x32_bf16 v[176:179], v[188:191], v[232:235], v[176:179]
    v_mfma_f32_16x16x32_bf16 v[180:183], v[188:191], v[236:239], v[180:183]
    s_waitcnt vmcnt(6)
    ds_read_b128 v[184:187], v198 offset:0
    s_waitcnt lgkmcnt(1)
    v_mfma_f32_16x16x32_bf16 v[176:179], v[192:195], v[240:243], v[176:179]
    v_mfma_f32_16x16x32_bf16 v[180:183], v[192:195], v[244:247], v[180:183]
    ds_read_b128 v[188:191], v249 offset:0
    s_waitcnt lgkmcnt(1)
    v_mfma_f32_16x16x32_bf16 v[168:171], v[184:187], v[200:203], 0
    v_mfma_f32_16x16x32_bf16 v[172:175], v[184:187], v[204:207], 0
    ds_read_b128 v[192:195], v198 offset:128
    s_waitcnt lgkmcnt(1)
    v_mfma_f32_16x16x32_bf16 v[168:171], v[188:191], v[208:211], v[168:171]
    v_mfma_f32_16x16x32_bf16 v[172:175], v[188:191], v[212:215], v[172:175]
    ds_read_b128 v[184:187], v249 offset:128
    s_waitcnt lgkmcnt(1)
    v_mfma_f32_16x16x32_bf16 v[168:171], v[192:195], v[216:219], v[168:171]
    v_mfma_f32_16x16x32_bf16 v[172:175], v[192:195], v[220:223], v[172:175]
    ds_read_b128 v[188:191], v198 offset:256
    s_waitcnt lgkmcnt(1)
    v_mfma_f32_16x16x32_bf16 v[168:171], v[184:187], v[224:227], v[168:171]
    v_mfma_f32_16x16x32_bf16 v[172:175], v[184:187], v[228:231], v[172:175]
    ds_read_b128 v[192:195], v249 offset:256
    v_cvt_pk_bf16_f32 v82, v176, v177
    v_cvt_pk_bf16_f32 v83, v178, v179
    v_cvt_pk_bf16_f32 v162, v180, v181
    v_cvt_pk_bf16_f32 v163, v182, v183
    s_waitcnt lgkmcnt(1)
    v_mfma_f32_16x16x32_bf16 v[168:171], v[188:191], v[232:235], v[168:171]
    v_mfma_f32_16x16x32_bf16 v[172:175], v[188:191], v[236:239], v[172:175]
    s_waitcnt vmcnt(0)
    ds_read_b128 v[184:187], v198 offset:6144
    s_waitcnt lgkmcnt(1)
    v_mfma_f32_16x16x32_bf16 v[168:171], v[192:195], v[240:243], v[168:171]
    v_mfma_f32_16x16x32_bf16 v[172:175], v[192:195], v[244:247], v[172:175]
    ds_read_b128 v[188:191], v249 offset:6144
    s_waitcnt lgkmcnt(1)
    v_mfma_f32_16x16x32_bf16 v[176:179], v[184:187], v[200:203], 0
    v_mfma_f32_16x16x32_bf16 v[180:183], v[184:187], v[204:207], 0
    ds_read_b128 v[192:195], v198 offset:6272
    s_waitcnt lgkmcnt(1)
    v_mfma_f32_16x16x32_bf16 v[176:179], v[188:191], v[208:211], v[176:179]
    v_mfma_f32_16x16x32_bf16 v[180:183], v[188:191], v[212:215], v[180:183]
    ds_read_b128 v[184:187], v249 offset:6272
    s_waitcnt lgkmcnt(1)
    v_mfma_f32_16x16x32_bf16 v[176:179], v[192:195], v[216:219], v[176:179]
    v_mfma_f32_16x16x32_bf16 v[180:183], v[192:195], v[220:223], v[180:183]
    ds_read_b128 v[188:191], v198 offset:6400
    s_waitcnt lgkmcnt(1)
    v_mfma_f32_16x16x32_bf16 v[176:179], v[184:187], v[224:227], v[176:179]
    v_mfma_f32_16x16x32_bf16 v[180:183], v[184:187], v[228:231], v[180:183]
    ds_read_b128 v[192:195], v249 offset:6400
    v_cvt_pk_bf16_f32 v84, v168, v169
    v_cvt_pk_bf16_f32 v85, v170, v171
    v_cvt_pk_bf16_f32 v164, v172, v173
    v_cvt_pk_bf16_f32 v165, v174, v175
    s_waitcnt lgkmcnt(1)
    v_mfma_f32_16x16x32_bf16 v[176:179], v[188:191], v[232:235], v[176:179]
    v_mfma_f32_16x16x32_bf16 v[180:183], v[188:191], v[236:239], v[180:183]
    s_waitcnt lgkmcnt(0)
    v_mfma_f32_16x16x32_bf16 v[176:179], v[192:195], v[240:243], v[176:179]
    v_mfma_f32_16x16x32_bf16 v[180:183], v[192:195], v[244:247], v[180:183]
    s_nop 6
    v_cvt_pk_bf16_f32 v86, v176, v177
    v_cvt_pk_bf16_f32 v87, v178, v179
    v_cvt_pk_bf16_f32 v166, v180, v181
    v_cvt_pk_bf16_f32 v167, v182, v183
    v_lshlrev_b32 v1, 4, v0
    v_mov_b32 v2, v1
    v_bfe_u32 v3, v0, 2, 2
    v_lshlrev_b32 v3, 1, v3
    v_and_b32 v7, 1, v0
    v_add_u32 v3, v3, v7
    v_lshlrev_b32 v3, 4, v3
    v_bfe_u32 v7, v0, 1, 1
    v_lshl_add_u32 v3, v7, 7, v3
    v_lshrrev_b32 v199, 4, v0
    v_lshl_add_u32 v3, v199, 8, v3
    v_add_u32 v3, 81920, v3
    v_mul_u32_u24 v4, 0xaaaa, v7
    v_add_u32 v4, 0x4444, v4
    v_lshrrev_b32 v5, 5, v0
    v_lshlrev_b32 v5, 8, v5
    v_bfe_u32 v7, v0, 1, 3
    v_lshl_add_u32 v5, v7, 5, v5
    v_bfe_u32 v7, v0, 4, 1
    v_lshl_add_u32 v5, v7, 4, v5
    v_and_b32 v7, 1, v0
    v_mul_u32_u24 v7, 528, v7
    v_xor_b32 v5, v5, v7
    s_lshl_b32 s73, s66, 10
    s_add_u32 s73, s73, 92160
    v_add_u32 v5, s73, v5
    s_lshl_b32 s73, s66, 11
    s_add_u32 s73, s73, 101376
    v_add_u32 v198, s73, v1
    v_mov_b32 v184, 0
    v_mov_b32 v188, 0x3f803f80
    v_mov_b32 v185, 0
    v_mov_b32 v189, 0x3f803f80
    v_mov_b32 v186, 0
    v_mov_b32 v190, 0x3f803f80
    v_mov_b32 v187, 0
    v_mov_b32 v191, 0x3f803f80
    v_mov_b32 v192, 0
    v_mov_b32 v193, 0
    v_mov_b32 v194, 0
    v_mov_b32 v195, 0
    v_mov_b32 v196, 0
    v_mov_b32 v197, 0
    s_lshl_b32 s81, s67, 11
    s_add_u32 s81, s81, 5645312
    s_lshl_b32 s82, s66, 2
    s_add_u32 s82, s82, 109568
    s_mul_i32 s85, s61, 20
    s_add_u32 s85, s85, s62
    s_lshl_b32 s85, s85, 2
    s_add_u32 s85, s85, s66
    s_lshl_b32 s85, s85, 5
    s_add_u32 s85, s85, 5521408
    v_and_b32 v7, 0x32, v0
    v_cmp_eq_u32 vcc, 0x32, v7
    v_mov_b32 v7, 0x40000000
    s_nop 0
    v_cndmask_b32 v199, v1, v7, vcc
    v_cmp_gt_u32 vcc, 8, v0
    v_lshlrev_b32 v253, 2, v0
    s_nop 0
    v_cndmask_b32 v253, v7, v253, vcc
    s_lshl_b32 s72, s66, 8
    s_add_u32 s72, s72, 151808
    v_lshl_add_u32 v252, v0, 2, s72
    s_mov_b32 s92, 0xaaaaaaaa
    s_mov_b32 s93, 0xaaaaaaaa
    s_mov_b32 s86, 0x55555555
    s_mov_b32 s87, 0xaaaaaaaa
    s_mov_b32 s88, 0x00005555
    s_mov_b32 s89, 0x0000aaaa
    s_mov_b32 s90, 0xffff0000
    s_mov_b32 s91, 0xffff0000
    v_bfe_u32 v7, v0, 1, 1
    v_lshlrev_b32 v7, 4, v7
    v_mov_b32 v208, 0x3f80
    v_lshlrev_b32 v208, v7, v208
    v_bfe_u32 v7, v0, 2, 2
    v_cmp_eq_u32 vcc, 0, v7
    s_nop 1
    v_cndmask_b32 v209, 0, v208, vcc
    v_cndmask_b32 v176, 0, v209, s[86:87]
    v_cndmask_b32 v180, 0, v209, s[88:89]
    v_cndmask_b32 v248, 0, v209, s[90:91]
    v_cmp_eq_u32 vcc, 1, v7
    s_nop 1
    v_cndmask_b32 v209, 0, v208, vcc
    v_cndmask_b32 v177, 0, v209, s[86:87]
    v_cndmask_b32 v181, 0, v209, s[88:89]
    v_cndmask_b32 v249, 0, v209, s[90:91]
    v_cmp_eq_u32 vcc, 2, v7
    s_nop 1
    v_cndmask_b32 v209, 0, v208, vcc
    v_cndmask_b32 v178, 0, v209, s[86:87]
    v_cndmask_b32 v182, 0, v209, s[88:89]
    v_cndmask_b32 v250, 0, v209, s[90:91]
    v_cmp_eq_u32 vcc, 3, v7
    s_nop 1
    v_cndmask_b32 v209, 0, v208, vcc
    v_cndmask_b32 v179, 0, v209, s[86:87]
    v_cndmask_b32 v183, 0, v209, s[88:89]
    v_cndmask_b32 v251, 0, v209, s[90:91]
    s_mov_b32 s64, -1
    s_barrier
    v_mov_b32 v7, 163584
    ds_read_b32 v7, v7 offset:32
    s_waitcnt lgkmcnt(0)
    v_readfirstlane_b32 s63, v7
    s_nop 0
    s_cmp_lt_i32 s63, 0
    s_cbranch_scc1 L_redo
    s_branch L_ZM_bulk
L_ZM_loop:
    s_and_b32 s83, s64, 3
    s_mul_i32 s83, s83, 475136
    s_add_u32 s83, s83, s81
    s_and_b32 s84, s64, 3
    s_mul_i32 s84, s84, 2048
    s_add_u32 s84, s84, s82
    v_mov_b32 v200, 0
    v_mov_b32 v201, 0
    v_mov_b32 v202, 0
    v_mov_b32 v203, 0
    v_mov_b32 v204, 0
    v_mov_b32 v205, 0
    v_mov_b32 v206, 0
    v_mov_b32 v207, 0
    s_add_u32 s72, s64, 1
    v_mov_b32 v6, s72
    v_add_u32 v208, s84, v1
    s_setprio 2
    s_waitcnt lgkmcnt(0)
    s_barrier
    ds_read_b128 v[216:219], v3 offset:0
    ds_read_b128 v[220:223], v3 offset:1024
    ds_read_b128 v[224:227], v3 offset:2048
    ds_read_b128 v[228:231], v3 offset:3072
    ds_read_b128 v[232:235], v3 offset:4096
    ds_read_b128 v[236:239], v3 offset:5120
    ds_read_b128 v[240:243], v3 offset:6144
    ds_read_b128 v[244:247], v3 offset:7168
    s_waitcnt lgkmcnt(7)
    v_smfmac_f32_16x16x64_bf16 v[200:203], v[216:219], v[8:15], v4
    v_smfmac_f32_16x16x64_bf16 v[204:207], v[216:219], v[88:95], v4
    ds_read_b128 v[216:219], v3 offset:8192
    s_waitcnt lgkmcnt(7)
    v_smfmac_f32_16x16x64_bf16 v[200:203], v[220:223], v[16:23], v4
    v_smfmac_f32_16x16x64_bf16 v[204:207], v[220:223], v[96:103], v4
    ds_read_b128 v[220:223], v3 offset:9216
    s_waitcnt lgkmcnt(7)
    v_smfmac_f32_16x16x64_bf16 v[200:203], v[224:227], v[24:31], v4
    v_smfmac_f32_16x16x64_bf16 v[204:207], v[224:227], v[104:111], v4
    s_waitcnt lgkmcnt(6)
    v_smfmac_f32_16x16x64_bf16 v[200:203], v[228:231], v[32:39], v4
    v_smfmac_f32_16x16x64_bf16 v[204:207], v[228:231], v[112:119], v4
    s_waitcnt lgkmcnt(5)
    v_smfmac_f32_16x16x64_bf16 v[200:203], v[232:235], v[40:47], v4
    v_smfmac_f32_16x16x64_bf16 v[204:207], v[232:235], v[120:127], v4
    s_waitcnt lgkmcnt(4)
    v_smfmac_f32_16x16x64_bf16 v[200:203], v[236:239], v[48:55], v4
    v_smfmac_f32_16x16x64_bf16 v[204:207], v[236:239], v[128:135], v4
    s_waitcnt lgkmcnt(3)
    v_smfmac_f32_16x16x64_bf16 v[200:203], v[240:243], v[56:63], v4
    v_smfmac_f32_16x16x64_bf16 v[204:207], v[240:243], v[136:143], v4
    s_waitcnt lgkmcnt(2)
    v_smfmac_f32_16x16x64_bf16 v[200:203], v[244:247], v[64:71], v4
    v_smfmac_f32_16x16x64_bf16 v[204:207], v[244:247], v[144:151], v4
    s_waitcnt lgkmcnt(1)
    v_smfmac_f32_16x16x64_bf16 v[200:203], v[216:219], v[72:79], v4
    v_smfmac_f32_16x16x64_bf16 v[204:207], v[216:219], v[152:159], v4
    s_waitcnt lgkmcnt(0)
    v_smfmac_f32_16x16x64_bf16 v[200:203], v[220:223], v[80:87], v4
    v_smfmac_f32_16x16x64_bf16 v[204:207], v[220:223], v[160:167], v4
    s_nop 6
    v_add_f32 v200, v200, v202
    v_add_f32 v201, v201, v203
    v_add_f32 v204, v204, v206
    v_add_f32 v205, v205, v207
    v_cvt_pk_bf16_f32 v184, v200, v201
    v_cvt_pk_bf16_f32 v186, v205, v204
    v_cvt_pk_bf16_f32 v202, v204, v205
    ds_write_b32 v208, v184
    ds_write_b32 v208, v202 offset:1024
    s_setprio 2
    buffer_load_dwordx4 v[224:227], v1, s[4:7], s83 offen sc1
    buffer_load_dwordx4 v[228:231], v199, s[4:7], s83 offen offset:1024 sc1
    s_sleep 2
Lpoll_57:
    buffer_load_dwordx4 v[232:235], v1, s[4:7], s83 offen sc1
    buffer_load_dwordx4 v[236:239], v199, s[4:7], s83 offen offset:1024 sc1
    s_waitcnt vmcnt(2)
    v_mfma_f32_16x16x32_bf16 v[220:223], v[228:231], v[248:251], 0
    v_mfma_f32_16x16x32_bf16 v[216:219], v[224:227], v[176:179], 0
    v_mfma_f32_16x16x32_bf16 v[216:219], v[228:231], v[180:183], v[216:219]
    v_max3_u32 v7, v224, v225, v226
    v_max3_u32 v7, v7, v227, v228
    v_max3_u32 v7, v7, v229, v230
    v_max_u32 v7, v7, v231
    v_cmp_eq_u32 vcc, -1, v7
    s_cbranch_vccnz Lpf_58
Ltail_60:
    buffer_store_dword v6, v253, s[4:7], s85 offen
    ds_write_b32 v252, v6
    v_add_f32 v220, v220, v222
    v_add_f32 v221, v221, v223
    v_max3_f32 v223, v216, v217, v218
    v_cndmask_b32 v220, v220, v221, s[92:93]
    v_max3_f32 v223, v223, v219, v220
    s_cmp_lg_u32 s63, 0
    s_cbranch_scc1 Lslow_61
Lback_62:
    v_max_f32_dpp v223, v223, v223 quad_perm:[1,0,3,2] row_mask:0xf bank_mask:0xf
    v_mov_b32 v222, v223
    s_nop 1
    v_permlane16_swap_b32 v223, v222
    v_max_f32 v223, v223, v222
    v_mov_b32 v222, v223
    s_nop 1
    v_permlane32_swap_b32 v223, v222
    v_max_f32 v223, v223, v222
    v_sub_f32 v216, v216, v223
    v_sub_f32 v217, v217, v223
    v_sub_f32 v218, v218, v223
    v_sub_f32 v219, v219, v223
    v_sub_f32 v220, v220, v223
    v_exp_f32 v220, v220
    v_exp_f32 v216, v216
    v_exp_f32 v217, v217
    v_exp_f32 v218, v218
    v_exp_f32 v219, v219
    v_mov_b32_dpp v221, v220 quad_perm:[1,0,3,2] row_mask:0xf bank_mask:0xf
    v_cvt_pk_bf16_f32 v200, v216, v217
    v_cvt_pk_bf16_f32 v201, v218, v219
    v_cvt_pk_bf16_f32 v194, v220, v221
    v_mov_b32_dpp v202, v200 quad_perm:[1,0,3,2] row_mask:0xf bank_mask:0xf
    v_mov_b32_dpp v203, v201 quad_perm:[1,0,3,2] row_mask:0xf bank_mask:0xf
    v_mfma_f32_16x16x32_bf16 v[212:215], v[188:191], v[194:197], 0
    v_mfma_f32_16x16x32_bf16 v[204:207], v[184:187], v[194:197], 0
    v_mfma_f32_16x16x32_bf16 v[208:211], v[184:187], v[192:195], 0
    v_mfma_f32_16x16x32_bf16 v[212:215], v[188:191], v[200:203], v[212:215]
    v_mfma_f32_16x16x32_bf16 v[204:207], v[168:171], v[200:203], v[204:207]
    v_mfma_f32_16x16x32_bf16 v[208:211], v[172:175], v[200:203], v[208:211]
    s_nop 5
    v_rcp_f32 v223, v212
    s_nop 0
    v_cndmask_b32 v204, v204, v208, s[92:93]
    v_cndmask_b32 v205, v205, v209, s[92:93]
    v_cndmask_b32 v206, v206, v210, s[92:93]
    v_cndmask_b32 v207, v207, v211, s[92:93]
    v_mul_f32 v204, v204, v223
    v_mul_f32 v205, v205, v223
    v_mul_f32 v206, v206, v223
    v_mul_f32 v207, v207, v223
    ds_write_b128 v5, v[204:207]
    s_waitcnt lgkmcnt(0)
    s_barrier
Ljoin_59:
    s_setprio 0
L_ZM_bulk:
    s_sleep 2
    s_waitcnt vmcnt(0)
    s_cmp_ge_i32 s64, 63
    s_cbranch_scc1 L_ZM_next
    ds_read_b128 v[216:219], v2 offset:0
    ds_read_b128 v[220:223], v2 offset:1024
    ds_read_b128 v[224:227], v2 offset:2048
    ds_read_b128 v[228:231], v2 offset:3072
    ds_read_b128 v[232:235], v2 offset:4096
    ds_read_b128 v[236:239], v2 offset:5120
    s_waitcnt lgkmcnt(4)
    v_mfma_f32_16x16x32_bf16 v[200:203], v[216:219], v[8:11], 0
    ds_read_b128 v[240:243], v2 offset:6144
    v_mfma_f32_16x16x32_bf16 v[208:211], v[216:219], v[88:91], 0
    ds_read_b128 v[244:247], v2 offset:7168
    v_mfma_f32_16x16x32_bf16 v[204:207], v[220:223], v[8:11], 0
    s_waitcnt lgkmcnt(4)
    v_mfma_f32_16x16x32_bf16 v[212:215], v[220:223], v[88:91], 0
    v_mfma_f32_16x16x32_bf16 v[200:203], v[224:227], v[12:15], v[200:203]
    ds_read_b128 v[216:219], v2 offset:8192
    v_mfma_f32_16x16x32_bf16 v[208:211], v[224:227], v[92:95], v[208:211]
    ds_read_b128 v[220:223], v2 offset:9216
    v_mfma_f32_16x16x32_bf16 v[204:207], v[228:231], v[12:15], v[204:207]
    s_waitcnt lgkmcnt(4)
    v_mfma_f32_16x16x32_bf16 v[212:215], v[228:231], v[92:95], v[212:215]
    v_mfma_f32_16x16x32_bf16 v[200:203], v[232:235], v[16:19], v[200:203]
    ds_read_b128 v[224:227], v2 offset:10240
    v_mfma_f32_16x16x32_bf16 v[208:211], v[232:235], v[96:99], v[208:211]
    ds_read_b128 v[228:231], v2 offset:11264
    v_mfma_f32_16x16x32_bf16 v[204:207], v[236:239], v[16:19], v[204:207]
    s_waitcnt lgkmcnt(4)
    v_mfma_f32_16x16x32_bf16 v[212:215], v[236:239], v[96:99], v[212:215]
    v_mfma_f32_16x16x32_bf16 v[200:203], v[240:243], v[20:23], v[200:203]
    ds_read_b128 v[232:235], v2 offset:12288
    v_mfma_f32_16x16x32_bf16 v[208:211], v[240:243], v[100:103], v[208:211]
    ds_read_b128 v[236:239], v2 offset:13312
    v_mfma_f32_16x16x32_bf16 v[204:207], v[244:247], v[20:23], v[204:207]
    s_waitcnt lgkmcnt(4)
    v_mfma_f32_16x16x32_bf16 v[212:215], v[244:247], v[100:103], v[212:215]
    v_mfma_f32_16x16x32_bf16 v[200:203], v[216:219], v[24:27], v[200:203]
    ds_read_b128 v[240:243], v2 offset:14336
    v_mfma_f32_16x16x32_bf16 v[208:211], v[216:219], v[104:107], v[208:211]
    ds_read_b128 v[244:247], v2 offset:15360
    v_mfma_f32_16x16x32_bf16 v[204:207], v[220:223], v[24:27], v[204:207]
    s_waitcnt lgkmcnt(4)
    v_mfma_f32_16x16x32_bf16 v[212:215], v[220:223], v[104:107], v[212:215]
    v_mfma_f32_16x16x32_bf16 v[200:203], v[224:227], v[28:31], v[200:203]
    ds_read_b128 v[216:219], v2 offset:16384
    v_mfma_f32_16x16x32_bf16 v[208:211], v[224:227], v[108:111], v[208:211]
    ds_read_b128 v[220:223], v2 offset:17408
    v_mfma_f32_16x16x32_bf16 v[204:207], v[228:231], v[28:31], v[204:207]
    s_waitcnt lgkmcnt(4)
    v_mfma_f32_16x16x32_bf16 v[212:215], v[228:231], v[108:111], v[212:215]
    v_mfma_f32_16x16x32_bf16 v[200:203], v[232:235], v[32:35], v[200:203]
    ds_read_b128 v[224:227], v2 offset:18432
    v_mfma_f32_16x16x32_bf16 v[208:211], v[232:235], v[112:115], v[208:211]
    ds_read_b128 v[228:231], v2 offset:19456
    v_mfma_f32_16x16x32_bf16 v[204:207], v[236:239], v[32:35], v[204:207]
    s_waitcnt lgkmcnt(4)
    v_mfma_f32_16x16x32_bf16 v[212:215], v[236:239], v[112:115], v[212:215]
    v_mfma_f32_16x16x32_bf16 v[200:203], v[240:243], v[36:39], v[200:203]
    ds_read_b128 v[232:235], v2 offset:20480
    v_mfma_f32_16x16x32_bf16 v[208:211], v[240:243], v[116:119], v[208:211]
    ds_read_b128 v[236:239], v2 offset:21504
    v_mfma_f32_16x16x32_bf16 v[204:207], v[244:247], v[36:39], v[204:207]
    s_waitcnt lgkmcnt(4)
    v_mfma_f32_16x16x32_bf16 v[212:215], v[244:247], v[116:119], v[212:215]
    v_mfma_f32_16x16x32_bf16 v[200:203], v[216:219], v[40:43], v[200:203]
    ds_read_b128 v[240:243], v2 offset:22528
    v_mfma_f32_16x16x32_bf16 v[208:211], v[216:219], v[120:123], v[208:211]
    ds_read_b128 v[244:247], v2 offset:23552
    v_mfma_f32_16x16x32_bf16 v[204:207], v[220:223], v[40:43], v[204:207]
    s_waitcnt lgkmcnt(4)
    v_mfma_f32_16x16x32_bf16 v[212:215], v[220:223], v[120:123], v[212:215]
    v_mfma_f32_16x16x32_bf16 v[200:203], v[224:227], v[44:47], v[200:203]
    ds_read_b128 v[216:219], v2 offset:24576
    v_mfma_f32_16x16x32_bf16 v[208:211], v[224:227], v[124:127], v[208:211]
    ds_read_b128 v[220:223], v2 offset:25600
    v_mfma_f32_16x16x32_bf16 v[204:207], v[228:231], v[44:47], v[204:207]
    s_waitcnt lgkmcnt(4)
    v_mfma_f32_16x16x32_bf16 v[212:215], v[228:231], v[124:127], v[212:215]
    v_mfma_f32_16x16x32_bf16 v[200:203], v[232:235], v[48:51], v[200:203]
    ds_read_b128 v[224:227], v2 offset:26624
    v_mfma_f32_16x16x32_bf16 v[208:211], v[232:235], v[128:131], v[208:211]
    ds_read_b128 v[228:231], v2 offset:27648
    v_mfma_f32_16x16x32_bf16 v[204:207], v[236:239], v[48:51], v[204:207]
    s_waitcnt lgkmcnt(4)
    v_mfma_f32_16x16x32_bf16 v[212:215], v[236:239], v[128:131], v[212:215]
    v_mfma_f32_16x16x32_bf16 v[200:203], v[240:243], v[52:55], v[200:203]
    ds_read_b128 v[232:235], v2 offset:28672
    v_mfma_f32_16x16x32_bf16 v[208:211], v[240:243], v[132:135], v[208:211]
    ds_read_b128 v[236:239], v2 offset:29696
    v_mfma_f32_16x16x32_bf16 v[204:207], v[244:247], v[52:55], v[204:207]
    s_waitcnt lgkmcnt(4)
    v_mfma_f32_16x16x32_bf16 v[212:215], v[244:247], v[132:135], v[212:215]
    v_mfma_f32_16x16x32_bf16 v[200:203], v[216:219], v[56:59], v[200:203]
    ds_read_b128 v[240:243], v2 offset:30720
    v_mfma_f32_16x16x32_bf16 v[208:211], v[216:219], v[136:139], v[208:211]
    ds_read_b128 v[244:247], v2 offset:31744
    v_mfma_f32_16x16x32_bf16 v[204:207], v[220:223], v[56:59], v[204:207]
    s_waitcnt lgkmcnt(4)
    v_mfma_f32_16x16x32_bf16 v[212:215], v[220:223], v[136:139], v[212:215]
    v_mfma_f32_16x16x32_bf16 v[200:203], v[224:227], v[60:63], v[200:203]
    ds_read_b128 v[216:219], v2 offset:32768
    v_mfma_f32_16x16x32_bf16 v[208:211], v[224:227], v[140:143], v[208:211]
    ds_read_b128 v[220:223], v2 offset:33792
    v_mfma_f32_16x16x32_bf16 v[204:207], v[228:231], v[60:63], v[204:207]
    s_waitcnt lgkmcnt(4)
    v_mfma_f32_16x16x32_bf16 v[212:215], v[228:231], v[140:143], v[212:215]
    v_mfma_f32_16x16x32_bf16 v[200:203], v[232:235], v[64:67], v[200:203]
    ds_read_b128 v[224:227], v2 offset:34816
    v_mfma_f32_16x16x32_bf16 v[208:211], v[232:235], v[144:147], v[208:211]
    ds_read_b128 v[228:231], v2 offset:35840
    v_mfma_f32_16x16x32_bf16 v[204:207], v[236:239], v[64:67], v[204:207]
    s_waitcnt lgkmcnt(4)
    v_mfma_f32_16x16x32_bf16 v[212:215], v[236:239], v[144:147], v[212:215]
    v_mfma_f32_16x16x32_bf16 v[200:203], v[240:243], v[68:71], v[200:203]
    ds_read_b128 v[232:235], v2 offset:36864
    v_mfma_f32_16x16x32_bf16 v[208:211], v[240:243], v[148:151], v[208:211]
    ds_read_b128 v[236:239], v2 offset:37888
    v_mfma_f32_16x16x32_bf16 v[204:207], v[244:247], v[68:71], v[204:207]
    s_waitcnt lgkmcnt(4)
    v_mfma_f32_16x16x32_bf16 v[212:215], v[244:247], v[148:151], v[212:215]
    v_mfma_f32_16x16x32_bf16 v[200:203], v[216:219], v[72:75], v[200:203]
    ds_read_b128 v[240:243], v2 offset:38912
    v_mfma_f32_16x16x32_bf16 v[208:211], v[216:219], v[152:155], v[208:211]
    ds_read_b128 v[244:247], v2 offset:39936
    v_mfma_f32_16x16x32_bf16 v[204:207], v[220:223], v[72:75], v[204:207]
    s_waitcnt lgkmcnt(4)
    v_mfma_f32_16x16x32_bf16 v[212:215], v[220:223], v[152:155], v[212:215]
    v_mfma_f32_16x16x32_bf16 v[200:203], v[224:227], v[76:79], v[200:203]
    v_mfma_f32_16x16x32_bf16 v[208:211], v[224:227], v[156:159], v[208:211]
    v_mfma_f32_16x16x32_bf16 v[204:207], v[228:231], v[76:79], v[204:207]
    s_waitcnt lgkmcnt(2)
    v_mfma_f32_16x16x32_bf16 v[212:215], v[228:231], v[156:159], v[212:215]
    v_mfma_f32_16x16x32_bf16 v[200:203], v[232:235], v[80:83], v[200:203]
    v_mfma_f32_16x16x32_bf16 v[208:211], v[232:235], v[160:163], v[208:211]
    v_mfma_f32_16x16x32_bf16 v[204:207], v[236:239], v[80:83], v[204:207]
    s_waitcnt lgkmcnt(0)
    v_mfma_f32_16x16x32_bf16 v[212:215], v[236:239], v[160:163], v[212:215]
    v_mfma_f32_16x16x32_bf16 v[200:203], v[240:243], v[84:87], v[200:203]
    v_mfma_f32_16x16x32_bf16 v[208:211], v[240:243], v[164:167], v[208:211]
    v_mfma_f32_16x16x32_bf16 v[204:207], v[244:247], v[84:87], v[204:207]
    v_mfma_f32_16x16x32_bf16 v[212:215], v[244:247], v[164:167], v[212:215]
    v_xor_b32 v2, 40960, v2
    s_nop 3
    v_cvt_pk_bf16_f32 v168, v200, v201
    v_cvt_pk_bf16_f32 v169, v202, v203
    v_cvt_pk_bf16_f32 v170, v204, v205
    v_cvt_pk_bf16_f32 v171, v206, v207
    v_cvt_pk_bf16_f32 v174, v208, v209
    v_cvt_pk_bf16_f32 v175, v210, v211
    v_cvt_pk_bf16_f32 v172, v212, v213
    v_cvt_pk_bf16_f32 v173, v214, v215
    ds_write_b128 v198, v[168:171]
    ds_write2_b64 v198, v[174:175], v[172:173] offset0:128 offset1:129
L_ZM_next:
    s_add_u32 s64, s64, 1
    s_cmp_lt_i32 s64, 64
    s_cbranch_scc1 L_ZM_loop
    s_endpgm
L_ZA:
    v_mov_b32 v188, -1
    v_mov_b32 v189, -1
    s_mov_b32 s20, s50
    s_and_b32 s21, s51, 0xffff
    s_mov_b32 s22, 1966080
    s_mov_b32 s23, 0x00020000
    s_mov_b32 s29, 139264
    s_lshr_b32 s73, s66, 1
    v_and_b32 v2, 1, v0
    v_bfe_u32 v3, v0, 1, 2
    v_lshl_add_u32 v2, v3, 2, v2
    v_bfe_u32 v3, v0, 3, 1
    v_lshl_add_u32 v2, v3, 1, v2
    v_lshl_add_u32 v2, s73, 4, v2
    v_lshrrev_b32 v3, 3, v2
    v_lshrrev_b32 v4, 4, v0
    v_cmp_eq_u32 vcc, v3, v4
    v_and_b32 v3, 1, v2
    v_lshlrev_b32 v3, 4, v3
    v_mov_b32 v4, 0x3f80
    v_lshlrev_b32 v3, v3, v4
    v_cndmask_b32 v3, 0, v3, vcc
    v_bfe_u32 v4, v2, 1, 2
    v_cmp_eq_u32 vcc, 0, v4
    s_nop 1
    v_cndmask_b32 v80, 0, v3, vcc
    v_cmp_eq_u32 vcc, 1, v4
    s_nop 1
    v_cndmask_b32 v81, 0, v3, vcc
    v_cmp_eq_u32 vcc, 2, v4
    s_nop 1
    v_cndmask_b32 v82, 0, v3, vcc
    v_cmp_eq_u32 vcc, 3, v4
    s_nop 1
    v_cndmask_b32 v83, 0, v3, vcc
    v_lshrrev_b32 v2, 2, v0
    v_mul_u32_u24 v2, 1280, v2
    v_and_b32 v3, 3, v0
    v_lshl_add_u32 v2, v3, 4, v2
    s_mul_i32 s80, s61, 245760
    s_lshl_b32 s73, s62, 6
    s_add_u32 s80, s80, s73
    s_and_b32 s73, s66, 1
    s_mul_i32 s91, s73, 12032
    s_cmp_ge_u32 s66, 2
    s_cselect_b32 s73, 12288, s29
    s_add_u32 s91, s91, s73
    v_and_b32 v3, 15, v0
    v_lshlrev_b32 v3, 6, v3
    v_and_b32 v4, 0x30, v0
    v_add3_u32 v3, v3, v4, s91
    s_add_u32 m0, s91, 0
    s_add_u32 s72, s80, 0
    buffer_load_dwordx4 v2, s[20:23], s72 offen lds
    s_add_u32 m0, s91, 1024
    s_add_u32 s72, s80, 20480
    buffer_load_dwordx4 v2, s[20:23], s72 offen lds
    s_add_u32 m0, s91, 2048
    s_add_u32 s72, s80, 40960
    buffer_load_dwordx4 v2, s[20:23], s72 offen lds
    s_add_u32 m0, s91, 3072
    s_add_u32 s72, s80, 61440
    buffer_load_dwordx4 v2, s[20:23], s72 offen lds
    s_add_u32 m0, s91, 4096
    s_add_u32 s72, s80, 81920
    buffer_load_dwordx4 v2, s[20:23], s72 offen lds
    s_add_u32 m0, s91, 5120
    s_add_u32 s72, s80, 102400
    buffer_load_dwordx4 v2, s[20:23], s72 offen lds
    s_add_u32 m0, s91, 6144
    s_add_u32 s72, s80, 122880
    buffer_load_dwordx4 v2, s[20:23], s72 offen lds
    s_add_u32 m0, s91, 7168
    s_add_u32 s72, s80, 143360
    buffer_load_dwordx4 v2, s[20:23], s72 offen lds
    s_add_u32 m0, s91, 8192
    s_add_u32 s72, s80, 163840
    buffer_load_dwordx4 v2, s[20:23], s72 offen lds
    s_waitcnt vmcnt(8)
    ds_read_b128 v[64:67], v3 offset:0
    s_add_u32 m0, s91, 9216
    s_add_u32 s72, s80, 184320
    buffer_load_dwordx4 v2, s[20:23], s72 offen lds
    s_waitcnt vmcnt(8)
    ds_read_b128 v[68:71], v3 offset:1024
    s_waitcnt lgkmcnt(1)
    v_mfma_f32_16x16x32_bf16 v[84:87], v[64:67], v[80:83], 0
    s_add_u32 m0, s91, 10240
    s_add_u32 s72, s80, 204800
    buffer_load_dwordx4 v2, s[20:23], s72 offen lds
    s_waitcnt vmcnt(8)
    ds_read_b128 v[72:75], v3 offset:2048
    s_waitcnt lgkmcnt(1)
    v_mfma_f32_16x16x32_bf16 v[88:91], v[68:71], v[80:83], 0
    s_nop 0
    v_cvt_pk_bf16_f32 v16, v84, v85
    v_cvt_pk_bf16_f32 v17, v86, v87
    s_add_u32 m0, s91, 0
    s_add_u32 s72, s80, 225280
    buffer_load_dwordx4 v2, s[20:23], s72 offen lds
    s_waitcnt vmcnt(8)
    ds_read_b128 v[64:67], v3 offset:3072
    s_waitcnt lgkmcnt(1)
    v_mfma_f32_16x16x32_bf16 v[92:95], v[72:75], v[80:83], 0
    v_cvt_pk_bf16_f32 v18, v88, v89
    v_cvt_pk_bf16_f32 v19, v90, v91
    s_waitcnt vmcnt(7)
    ds_read_b128 v[68:71], v3 offset:4096
    s_waitcnt lgkmcnt(1)
    v_mfma_f32_16x16x32_bf16 v[96:99], v[64:67], v[80:83], 0
    s_nop 1
    v_cvt_pk_bf16_f32 v20, v92, v93
    v_cvt_pk_bf16_f32 v21, v94, v95
    s_waitcnt vmcnt(6)
    ds_read_b128 v[72:75], v3 offset:5120
    s_waitcnt lgkmcnt(1)
    v_mfma_f32_16x16x32_bf16 v[84:87], v[68:71], v[80:83], 0
    v_cvt_pk_bf16_f32 v22, v96, v97
    v_cvt_pk_bf16_f32 v23, v98, v99
    s_waitcnt vmcnt(5)
    ds_read_b128 v[64:67], v3 offset:6144
    s_waitcnt lgkmcnt(1)
    v_mfma_f32_16x16x32_bf16 v[88:91], v[72:75], v[80:83], 0
    s_nop 1
    v_cvt_pk_bf16_f32 v24, v84, v85
    v_cvt_pk_bf16_f32 v25, v86, v87
    s_waitcnt vmcnt(4)
    ds_read_b128 v[68:71], v3 offset:7168
    s_waitcnt lgkmcnt(1)
    v_mfma_f32_16x16x32_bf16 v[92:95], v[64:67], v[80:83], 0
    v_cvt_pk_bf16_f32 v26, v88, v89
    v_cvt_pk_bf16_f32 v27, v90, v91
    s_waitcnt vmcnt(3)
    ds_read_b128 v[72:75], v3 offset:8192
    s_waitcnt lgkmcnt(1)
    v_mfma_f32_16x16x32_bf16 v[96:99], v[68:71], v[80:83], 0
    s_nop 1
    v_cvt_pk_bf16_f32 v28, v92, v93
    v_cvt_pk_bf16_f32 v29, v94, v95
    s_waitcnt vmcnt(2)
    ds_read_b128 v[64:67], v3 offset:9216
    s_waitcnt lgkmcnt(1)
    v_mfma_f32_16x16x32_bf16 v[84:87], v[72:75], v[80:83], 0
    v_cvt_pk_bf16_f32 v30, v96, v97
    v_cvt_pk_bf16_f32 v31, v98, v99
    s_waitcnt vmcnt(1)
    ds_read_b128 v[68:71], v3 offset:10240
    s_waitcnt lgkmcnt(1)
    v_mfma_f32_16x16x32_bf16 v[88:91], v[64:67], v[80:83], 0
    s_nop 1
    v_cvt_pk_bf16_f32 v32, v84, v85
    v_cvt_pk_bf16_f32 v33, v86, v87
    s_waitcnt vmcnt(0)
    ds_read_b128 v[72:75], v3 offset:0
    s_waitcnt lgkmcnt(1)
    v_mfma_f32_16x16x32_bf16 v[92:95], v[68:71], v[80:83], 0
    v_cvt_pk_bf16_f32 v34, v88, v89
    v_cvt_pk_bf16_f32 v35, v90, v91
    s_waitcnt lgkmcnt(0)
    v_mfma_f32_16x16x32_bf16 v[96:99], v[72:75], v[80:83], 0
    s_nop 3
    v_cvt_pk_bf16_f32 v36, v92, v93
    v_cvt_pk_bf16_f32 v37, v94, v95
    s_nop 1
    v_cvt_pk_bf16_f32 v38, v96, v97
    v_cvt_pk_bf16_f32 v39, v98, v99
    v_lshlrev_b32 v7, 3, v0
    s_mul_i32 s91, s66, 5
    s_add_u32 s91, s91, 1
    s_lshr_b32 s91, s91, 1
    s_min_u32 s91, s91, 7
    s_lshl_b32 s91, s91, 10
    v_add_u32 v6, s91, v1
    v_add_u32 v5, 81920, v6
    v_lshrrev_b32 v8, 5, v0
    v_lshlrev_b32 v8, 4, v8
    v_xor_b32 v8, v8, v1
    v_add_u32 v8, 92160, v8
    s_lshr_b32 s73, s66, 1
    s_lshl_b32 s73, s73, 10
    s_add_u32 s73, s73, 101376
    v_add_u32 v9, s73, v1
    s_and_b32 s74, s66, 1
    s_mul_i32 s73, s74, 6144
    s_add_u32 s73, s73, 117760
    v_add_u32 v10, s73, v1
    s_mul_i32 s73, s74, 1280
    s_add_u32 s73, s73, 130048
    v_add_u32 v11, s73, v1
    s_add_u32 s73, s73, 1024
    v_lshl_add_u32 v12, v0, 2, s73
    s_mul_i32 s80, s61, 10240
    s_add_u32 s67, s80, s91
    s_add_u32 s67, s67, 16777216
    s_add_u32 s91, s91, 130048
    s_add_u32 s80, s80, 5563392
    s_lshr_b32 s81, s62, 1
    s_lshl_b32 s81, s81, 14
    s_and_b32 s73, s62, 1
    s_lshl_b32 s73, s73, 12
    s_add_u32 s81, s81, s73
    s_add_u32 s81, s81, 4194304
    s_lshl_b32 s73, s61, 9
    s_add_u32 s81, s81, s73
    s_mul_i32 s82, s61, 12288
    s_mul_i32 s90, s66, 3072
    s_add_u32 s82, s82, s90
    s_add_u32 s82, s82, 8388608
    s_add_u32 s90, s90, 117760
    s_lshl_b32 s86, s62, 3
    s_add_u32 s86, s86, s61
    s_lshl_b32 s86, s86, 2
    s_add_u32 s86, s86, s66
    s_lshl_b32 s86, s86, 9
    s_add_u32 s86, s86, 24182784
    s_mul_i32 s88, s66, 10240
    s_add_u32 s87, s88, 40960
    s_lshl_b32 s89, s88, 1
    s_add_u32 s89, s89, 40960
    s_add_u32 s88, s88, 40960
    v_lshrrev_b32 v2, 5, v0
    v_bfe_u32 v3, v0, 4, 1
    v_and_b32 v192, 15, v0
    v_lshlrev_b32 v192, 3, v192
    v_lshl_add_u32 v192, v3, 10, v192
    v_lshl_add_u32 v192, v2, 11, v192
    s_lshr_b32 s73, s61, 2
    s_lshl_b32 s73, s73, 9
    s_and_b32 s74, s61, 3
    s_lshl_b32 s74, s74, 7
    s_add_u32 s73, s73, s74
    s_lshl_b32 s74, s62, 14
    s_add_u32 s73, s73, s74
    v_add_u32 v192, s73, v192
    v_and_b32 v193, 3, v0
    v_mul_u32_u24 v193, 1280, v193
    v_lshl_add_u32 v193, v3, 5, v193
    v_lshl_add_u32 v193, v2, 3, v193
    v_bfe_u32 v4, v0, 2, 1
    v_lshl_add_u32 v193, v4, 4, v193
    v_bfe_u32 v4, v0, 3, 1
    v_lshl_add_u32 v193, v4, 2, v193
    s_mul_i32 s73, s61, 5120
    s_lshl_b32 s74, s62, 6
    s_add_u32 s73, s73, s74
    v_add_u32 v193, s73, v193
    s_cmp_lg_u32 s66, 3
    s_cbranch_scc1 Lgw_skip_1066
    v_mov_b32 v3, 163632
    s_mov_b32 s72, 1
Lflag_1072:
    ds_read_b32 v2, v3
    s_waitcnt lgkmcnt(0)
    v_cmp_gt_i32 vcc, s72, v2
    s_cbranch_vccz Lflagd_1073
    s_sleep 4
    s_branch Lflag_1072
Lflagd_1073:
    s_mov_b32 s73, 16
    v_and_b32 v4, 7, v0
    v_lshlrev_b32 v4, 5, v4
    s_cmp_lg_u32 s71, 0
    s_cbranch_scc1 Lgw_m1_1069
Lgw_1067:
    buffer_load_dwordx2 v[2:3], v4, s[8:11], 0 offen offset:8 sc1
    s_waitcnt vmcnt(0)
    v_xor_b32 v2, -1, v2
    v_xor_b32 v3, 0x2000, v3
    v_or_b32 v2, v2, v3
    v_cmp_ne_u32 vcc, 0, v2
    s_cbranch_vccnz Lgw_x_1070
Lgw_done_1068:
    buffer_load_dwordx2 v[2:3], off, s[8:11], s73 sc1
    s_mov_b32 s75, 0
    s_mov_b32 s76, 0
    s_add_u32 m0, s76, 0
    s_add_u32 s77, s75, 0
    buffer_load_dwordx4 v1, s[4:7], s77 offen lds
    buffer_load_dwordx4 v1, s[4:7], s77 offen offset:1024 lds
    buffer_load_dwordx4 v1, s[4:7], s77 offen offset:2048 lds
    buffer_load_dwordx4 v1, s[4:7], s77 offen offset:3072 lds
    s_add_u32 m0, s76, 4096
    s_add_u32 s77, s75, 4096
    buffer_load_dwordx4 v1, s[4:7], s77 offen lds
    buffer_load_dwordx4 v1, s[4:7], s77 offen offset:1024 lds
    buffer_load_dwordx4 v1, s[4:7], s77 offen offset:2048 lds
    buffer_load_dwordx4 v1, s[4:7], s77 offen offset:3072 lds
    s_add_u32 m0, s76, 8192
    s_add_u32 s77, s75, 8192
    buffer_load_dwordx4 v1, s[4:7], s77 offen lds
    buffer_load_dwordx4 v1, s[4:7], s77 offen offset:1024 lds
    buffer_load_dwordx4 v1, s[4:7], s77 offen offset:2048 lds
    buffer_load_dwordx4 v1, s[4:7], s77 offen offset:3072 lds
    s_add_u32 m0, s76, 12288
    s_add_u32 s77, s75, 12288
    buffer_load_dwordx4 v1, s[4:7], s77 offen lds
    buffer_load_dwordx4 v1, s[4:7], s77 offen offset:1024 lds
    buffer_load_dwordx4 v1, s[4:7], s77 offen offset:2048 lds
    buffer_load_dwordx4 v1, s[4:7], s77 offen offset:3072 lds
    s_add_u32 m0, s76, 16384
    s_add_u32 s77, s75, 16384
    buffer_load_dwordx4 v1, s[4:7], s77 offen lds
    buffer_load_dwordx4 v1, s[4:7], s77 offen offset:1024 lds
    buffer_load_dwordx4 v1, s[4:7], s77 offen offset:2048 lds
    buffer_load_dwordx4 v1, s[4:7], s77 offen offset:3072 lds
    s_add_u32 m0, s76, 20480
    s_add_u32 s77, s75, 20480
    buffer_load_dwordx4 v1, s[4:7], s77 offen lds
    buffer_load_dwordx4 v1, s[4:7], s77 offen offset:1024 lds
    buffer_load_dwordx4 v1, s[4:7], s77 offen offset:2048 lds
    buffer_load_dwordx4 v1, s[4:7], s77 offen offset:3072 lds
    s_add_u32 m0, s76, 24576
    s_add_u32 s77, s75, 24576
    buffer_load_dwordx4 v1, s[4:7], s77 offen lds
    buffer_load_dwordx4 v1, s[4:7], s77 offen offset:1024 lds
    buffer_load_dwordx4 v1, s[4:7], s77 offen offset:2048 lds
    buffer_load_dwordx4 v1, s[4:7], s77 offen offset:3072 lds
    s_add_u32 m0, s76, 28672
    s_add_u32 s77, s75, 28672
    buffer_load_dwordx4 v1, s[4:7], s77 offen lds
    buffer_load_dwordx4 v1, s[4:7], s77 offen offset:1024 lds
    buffer_load_dwordx4 v1, s[4:7], s77 offen offset:2048 lds
    buffer_load_dwordx4 v1, s[4:7], s77 offen offset:3072 lds
    s_add_u32 m0, s76, 32768
    s_add_u32 s77, s75, 32768
    buffer_load_dwordx4 v1, s[4:7], s77 offen lds
    buffer_load_dwordx4 v1, s[4:7], s77 offen offset:1024 lds
    buffer_load_dwordx4 v1, s[4:7], s77 offen offset:2048 lds
    buffer_load_dwordx4 v1, s[4:7], s77 offen offset:3072 lds
    s_add_u32 m0, s76, 36864
    s_add_u32 s77, s75, 36864
    buffer_load_dwordx4 v1, s[4:7], s77 offen lds
    buffer_load_dwordx4 v1, s[4:7], s77 offen offset:1024 lds
    buffer_load_dwordx4 v1, s[4:7], s77 offen offset:2048 lds
    buffer_load_dwordx4 v1, s[4:7], s77 offen offset:3072 lds
    s_waitcnt vmcnt(0)
Lgw_r_1071:
    v_mov_b32 v4, 163584
    ds_write_b64 v4, v[2:3] offset:32
    s_waitcnt lgkmcnt(0)
Lgw_skip_1066:
    s_waitcnt vmcnt(0)
    s_barrier
    v_mov_b32 v2, 163584
    ds_read_b32 v2, v2 offset:32
    s_waitcnt lgkmcnt(0)
    v_readfirstlane_b32 s63, v2
    s_nop 0
    s_cmp_lt_i32 s63, 0
    s_cbranch_scc1 L_redo
    v_mov_b32 v2, 163584
    ds_read_b32 v2, v2 offset:36
    s_waitcnt lgkmcnt(0)
    v_readfirstlane_b32 s72, v2
    s_nop 0
    s_cmp_gt_i32 s72, 0
    s_cselect_b32 s72, 8192, 0
    s_lshl_b32 s77, s61, 11
    s_and_b32 s77, s77, 8192
    s_xor_b32 s72, s72, s77
    s_add_u32 s81, s81, s72
    v_and_b32 v13, 3, v0
    v_mul_u32_u24 v13, 260, v13
    v_add_u32 v13, 151808, v13
    v_and_b32 v14, 3, v0
    v_bfe_u32 v2, v0, 2, 2
    v_lshl_add_u32 v14, v2, 4, v14
    v_lshrrev_b32 v2, 4, v0
    v_lshl_add_u32 v14, v2, 2, v14
    v_lshlrev_b32 v14, 2, v14
    s_add_u32 m0, s88, 0
    s_add_u32 s77, s87, 0
    buffer_load_dwordx4 v1, s[4:7], s77 offen lds
    buffer_load_dwordx4 v1, s[4:7], s77 offen offset:1024 lds
    buffer_load_dwordx4 v1, s[4:7], s77 offen offset:2048 lds
    buffer_load_dwordx4 v1, s[4:7], s77 offen offset:3072 lds
    s_add_u32 m0, s88, 4096
    s_add_u32 s77, s87, 4096
    buffer_load_dwordx4 v1, s[4:7], s77 offen lds
    buffer_load_dwordx4 v1, s[4:7], s77 offen offset:1024 lds
    buffer_load_dwordx4 v1, s[4:7], s77 offen offset:2048 lds
    buffer_load_dwordx4 v1, s[4:7], s77 offen offset:3072 lds
    s_add_u32 m0, s88, 8192
    s_add_u32 s77, s87, 8192
    buffer_load_dwordx4 v1, s[4:7], s77 offen lds
    buffer_load_dwordx4 v1, s[4:7], s77 offen offset:1024 lds
    s_add_u32 s87, s87, 40960
    s_sub_u32 s88, s89, s88
L_ZA_loop:
    s_and_b32 s83, s64, 3
    s_mul_i32 s83, s83, 475136
    s_add_u32 s83, s83, s80
    s_waitcnt vmcnt(0)
    s_cmp_lg_u32 s66, 2
    s_cbranch_scc1 L_ZA_nf
    s_cmp_lt_i32 s64, 6
    s_cbranch_scc1 L_ZA_nf
    v_and_b32 v175, 0xffff0000, v173
    v_lshlrev_b32 v174, 16, v173
    v_and_b32 v173, 0xffff0000, v172
    v_lshlrev_b32 v172, 16, v172
    v_and_b32 v179, 0xffff0000, v177
    v_lshlrev_b32 v178, 16, v177
    v_and_b32 v177, 0xffff0000, v176
    v_lshlrev_b32 v176, 16, v176
    v_and_b32 v183, 0xffff0000, v181
    v_lshlrev_b32 v182, 16, v181
    v_and_b32 v181, 0xffff0000, v180
    v_lshlrev_b32 v180, 16, v180
    v_and_b32 v187, 0xffff0000, v185
    v_lshlrev_b32 v186, 16, v185
    v_and_b32 v185, 0xffff0000, v184
    v_lshlrev_b32 v184, 16, v184
    v_add_f32 v172, v172, v176
    v_add_f32 v180, v180, v184
    v_add_f32 v173, v173, v177
    v_add_f32 v181, v181, v185
    v_add_f32 v174, v174, v178
    v_add_f32 v182, v182, v186
    v_add_f32 v175, v175, v179
    v_add_f32 v183, v183, v187
    v_add_f32 v172, v172, v180
    v_add_f32 v173, v173, v181
    v_add_f32 v174, v174, v182
    v_add_f32 v175, v175, v183
    v_and_b32 v191, 0xffff0000, v190
    v_lshlrev_b32 v190, 16, v190
    v_permlane32_swap_b32 v172, v174
    v_permlane32_swap_b32 v173, v175
    v_add_f32 v172, v172, v174
    v_add_f32 v173, v173, v175
    v_add_f32 v172, v172, v190
    v_add_f32 v173, v173, v191
    v_cvt_pk_bf16_f32 v172, v172, v173
    buffer_store_dword v172, v193, s[16:19], s28 offen
L_ZA_nf:
Lpoll_1074:
    buffer_load_dwordx4 v[64:67], v6, s[4:7], s83 offen offset:0 sc1
    buffer_load_dwordx4 v[68:71], v6, s[4:7], s83 offen offset:1024 sc1
    buffer_load_dwordx4 v[72:75], v6, s[4:7], s83 offen offset:2048 sc1
    s_waitcnt vmcnt(0)
    ds_write_b128 v5, v[64:67] offset:0
    ds_write_b128 v5, v[68:71] offset:1024
    ds_write_b128 v5, v[72:75] offset:2048
    v_max3_u32 v2, v64, v65, v66
    v_max3_u32 v2, v2, v67, v68
    v_max3_u32 v2, v2, v69, v70
    v_max3_u32 v2, v2, v71, v72
    v_max3_u32 v2, v2, v73, v74
    v_max_u32 v2, v2, v75
    v_cmp_eq_u32 vcc, -1, v2
    s_cbranch_vccnz Lretry_1075
Ldone_1076:
    s_add_u32 s72, s64, 1
    s_and_b32 s73, s72, 3
    s_lshl_b32 s73, s73, 11
    v_add_u32 v3, s73, v9
    s_add_u32 s74, s64, 6
    s_and_b32 s74, s74, 7
    s_mul_i32 s74, s74, 98304
    s_add_u32 s74, s74, s82
    s_waitcnt lgkmcnt(0)
    s_barrier
    s_add_u32 m0, s90, 0
    s_add_u32 s77, s74, 0
    buffer_load_dwordx4 v1, s[4:7], s77 offen sc1 lds
    buffer_load_dwordx4 v1, s[4:7], s77 offen offset:1024 sc1 lds
    buffer_load_dwordx4 v1, s[4:7], s77 offen offset:2048 sc1 lds
    s_add_u32 m0, s88, 0
    s_add_u32 s77, s87, 0
    buffer_load_dwordx4 v1, s[4:7], s77 offen lds
    buffer_load_dwordx4 v1, s[4:7], s77 offen offset:1024 lds
    buffer_load_dwordx4 v1, s[4:7], s77 offen offset:2048 lds
    ds_read_b128 v[148:151], v11 offset:0
    ds_read_b128 v[152:155], v11 offset:2560
    ds_read_b128 v[156:159], v11 offset:5120
    ds_read_b128 v[160:163], v11 offset:7680
    ds_read_b32 v164, v12 offset:0
    ds_read_b32 v165, v12 offset:2560
    ds_read_b32 v166, v12 offset:5120
    ds_read_b32 v167, v12 offset:7680
    ds_read_b128 v[168:171], v3 offset:8192
    ds_read_b128 v[196:199], v9 offset:0
    ds_read_b128 v[200:203], v9 offset:2048
    ds_read_b128 v[204:207], v9 offset:4096
    ds_read_b128 v[208:211], v9 offset:6144
    s_add_u32 s84, s64, 2
    s_and_b32 s84, s84, 3
    s_mul_i32 s84, s84, 327680
    s_add_u32 s84, s84, s81
    s_add_u32 s73, s84, 163840
    s_xor_b32 s74, s73, 8192
    s_add_u32 s69, s84, 0
    s_xor_b32 s68, s69, 8192
    s_waitcnt lgkmcnt(9)
    v_mfma_f32_16x16x32_bf16 v[84:87], v[132:135], v[148:151], v[84:87]
    v_mfma_f32_16x16x32_bf16 v[84:87], v[136:139], v[152:155], v[84:87]
    v_mfma_f32_16x16x32_bf16 v[84:87], v[140:143], v[156:159], v[84:87]
    v_mfma_f32_16x16x32_bf16 v[84:87], v[144:147], v[160:163], v[84:87]
    s_waitcnt lgkmcnt(4)
    v_mfma_f32_16x16x32_bf16 v[84:87], v[168:171], v[164:167], v[84:87]
    s_waitcnt vmcnt(0) lgkmcnt(0)
    s_cmp_eq_u32 s66, 0
    s_cbranch_scc1 L_ZA_b2
    s_and_b32 s84, s64, 3
    s_mul_i32 s84, s84, 327680
    s_add_u32 s84, s84, s81
Lflag_1077:
    ds_read_b32 v2, v13
    s_waitcnt lgkmcnt(0)
    v_cmp_gt_i32 vcc, s72, v2
    s_cbranch_vccz Lflagd_1078
    s_sleep 2
    s_branch Lflag_1077
Lflagd_1078:
    s_cmp_eq_u32 s66, 2
    s_cbranch_scc1 L_ZA_n2
    s_cmp_eq_u32 s66, 3
    s_cbranch_scc1 L_ZA_n3
    s_add_u32 s74, s84, 0
    buffer_store_dwordx2 v[188:189], v7, s[4:7], s74 offen sc1
    s_xor_b32 s74, s74, 8192
    buffer_store_dwordx2 v[188:189], v7, s[4:7], s74 offen sc1
    s_add_u32 s74, s84, 163840
    buffer_store_dwordx2 v[188:189], v7, s[4:7], s74 offen sc1
    s_xor_b32 s74, s74, 8192
    buffer_store_dwordx2 v[188:189], v7, s[4:7], s74 offen sc1
    s_branch L_ZA_b2
L_ZA_n2:
    s_cmp_lt_i32 s64, 5
    s_cbranch_scc1 L_ZA_b2
    s_sub_u32 s74, s64, 5
    s_mul_i32 s75, s74, 327680
    s_add_u32 s75, s75, 25165824
    s_mul_i32 s28, s74, 40960
    buffer_load_dword v190, v193, s[12:15], s28 offen
    buffer_load_dwordx2 v[172:173], v192, s[4:7], s75 offen sc1
    s_add_u32 s75, s75, 4096
    buffer_load_dwordx2 v[176:177], v192, s[4:7], s75 offen sc1
    s_add_u32 s75, s75, 4096
    buffer_load_dwordx2 v[180:181], v192, s[4:7], s75 offen sc1
    s_add_u32 s75, s75, 4096
    buffer_load_dwordx2 v[184:185], v192, s[4:7], s75 offen sc1
    s_branch L_ZA_b2
L_ZA_n3:
    s_add_u32 s72, s64, 3
    s_mul_i32 s72, s72, 40960
    s_lshl_b32 s73, s62, 11
    s_add_u32 s72, s72, s73
    v_lshlrev_b32 v2, 5, v0
    buffer_load_dword v190, v2, s[4:7], s72 offen
L_ZA_b2:
    s_setprio 3
    s_cmp_lg_u32 s66, 0
    s_barrier
    s_cbranch_scc1 L_ZA_n0
    ds_read_b128 v[64:67], v8 offset:0
    ds_read_b128 v[68:71], v8 offset:1024
    ds_read_b128 v[72:75], v8 offset:2048
    ds_read_b128 v[76:79], v8 offset:3072
    s_waitcnt lgkmcnt(2)
    v_add_f32 v64, v64, v68
    v_add_f32 v65, v65, v69
    v_add_f32 v66, v66, v70
    v_add_f32 v67, v67, v71
    s_waitcnt lgkmcnt(1)
    v_add_f32 v64, v64, v72
    v_add_f32 v65, v65, v73
    v_add_f32 v66, v66, v74
    v_add_f32 v67, v67, v75
    s_waitcnt lgkmcnt(0)
    v_add_f32 v64, v64, v76
    v_add_f32 v65, v65, v77
    v_add_f32 v66, v66, v78
    v_add_f32 v67, v67, v79
    v_cvt_pk_bf16_f32 v64, v64, v65
    v_cvt_pk_bf16_f32 v65, v66, v67
    v_min_u32 v64, -2, v64
    v_min_u32 v65, -2, v65
    buffer_store_dwordx2 v[64:65], v7, s[4:7], s74 offen sc1
    buffer_store_dwordx2 v[64:65], v7, s[4:7], s73 offen sc1
    buffer_store_dwordx2 v[64:65], v7, s[4:7], s68 offen sc1
    buffer_store_dwordx2 v[64:65], v7, s[4:7], s69 offen sc1
    s_branch L_ZA_st
L_ZA_n0:
    s_sleep 3
L_ZA_st:
    s_setprio 1
    v_cvt_pk_bf16_f32 v212, v84, v85
    v_cvt_pk_bf16_f32 v213, v86, v87
    ds_bpermute_b32 v212, v14, v212
    ds_bpermute_b32 v213, v14, v213
    s_waitcnt lgkmcnt(0)
    buffer_store_dwordx2 v[212:213], v7, s[4:7], s86 offen sc1
    s_add_u32 s86, s86, 327680
    s_add_u32 s74, s64, 2
    s_and_b32 s74, s74, 3
    s_mul_i32 s74, s74, 81920
    s_add_u32 s74, s74, s67
    s_add_u32 m0, s91, 0
    s_add_u32 s77, s74, 0
    buffer_load_dwordx4 v1, s[4:7], s77 offen sc1 lds
    buffer_load_dwordx4 v1, s[4:7], s77 offen offset:1024 sc1 lds
    buffer_load_dwordx4 v1, s[4:7], s77 offen offset:2048 sc1 lds
    s_add_u32 m0, s88, 0
    s_add_u32 s77, s87, 0
    buffer_load_dwordx4 v1, s[4:7], s77 offen offset:3072 lds
    s_add_u32 m0, s88, 4096
    s_add_u32 s77, s87, 4096
    buffer_load_dwordx4 v1, s[4:7], s77 offen lds
    buffer_load_dwordx4 v1, s[4:7], s77 offen offset:1024 lds
    buffer_load_dwordx4 v1, s[4:7], s77 offen offset:2048 lds
    buffer_load_dwordx4 v1, s[4:7], s77 offen offset:3072 lds
    s_add_u32 m0, s88, 8192
    s_add_u32 s77, s87, 8192
    buffer_load_dwordx4 v1, s[4:7], s77 offen lds
    buffer_load_dwordx4 v1, s[4:7], s77 offen offset:1024 lds
    s_add_u32 s87, s87, 40960
    s_sub_u32 s88, s89, s88
    ds_read_b128 v[40:43], v10 offset:0
    ds_read_b128 v[44:47], v10 offset:1024
    ds_read_b128 v[48:51], v10 offset:2048
    ds_read_b128 v[52:55], v10 offset:3072
    ds_read_b128 v[56:59], v10 offset:4096
    ds_read_b128 v[60:63], v10 offset:5120
    v_mov_b32 v147, v131
    v_mov_b32 v146, v130
    v_mov_b32 v145, v129
    v_mov_b32 v144, v128
    v_mov_b32 v143, v127
    v_mov_b32 v142, v126
    v_mov_b32 v141, v125
    v_mov_b32 v140, v124
    v_mov_b32 v139, v123
    v_mov_b32 v138, v122
    v_mov_b32 v137, v121
    v_mov_b32 v136, v120
    v_mov_b32 v135, v119
    v_mov_b32 v134, v118
    v_mov_b32 v133, v117
    v_mov_b32 v132, v116
    v_mov_b32 v131, v115
    v_mov_b32 v130, v114
    v_mov_b32 v129, v113
    v_mov_b32 v128, v112
    v_mov_b32 v127, v111
    v_mov_b32 v126, v110
    v_mov_b32 v125, v109
    v_mov_b32 v124, v108
    v_mov_b32 v123, v107
    v_mov_b32 v122, v106
    v_mov_b32 v121, v105
    v_mov_b32 v120, v104
    v_mov_b32 v119, v103
    v_mov_b32 v118, v102
    v_mov_b32 v117, v101
    v_mov_b32 v116, v100
    v_mov_b32 v100, v196
    v_mov_b32 v101, v197
    v_mov_b32 v102, v198
    v_mov_b32 v103, v199
    v_mov_b32 v104, v200
    v_mov_b32 v105, v201
    v_mov_b32 v106, v202
    v_mov_b32 v107, v203
    v_mov_b32 v108, v204
    v_mov_b32 v109, v205
    v_mov_b32 v110, v206
    v_mov_b32 v111, v207
    v_mov_b32 v112, v208
    v_mov_b32 v113, v209
    v_mov_b32 v114, v210
    v_mov_b32 v115, v211
    s_waitcnt lgkmcnt(0)
    v_mfma_f32_16x16x32_bf16 v[84:87], v[16:19], v[40:43], 0
    v_mfma_f32_16x16x32_bf16 v[84:87], v[20:23], v[44:47], v[84:87]
    v_mfma_f32_16x16x32_bf16 v[84:87], v[24:27], v[48:51], v[84:87]
    v_mfma_f32_16x16x32_bf16 v[84:87], v[28:31], v[52:55], v[84:87]
    v_mfma_f32_16x16x32_bf16 v[84:87], v[32:35], v[56:59], v[84:87]
    v_mfma_f32_16x16x32_bf16 v[84:87], v[36:39], v[60:63], v[84:87]
    s_setprio 0
    s_add_u32 s64, s64, 1
    s_cmp_lt_i32 s64, 64
    s_cbranch_scc1 L_ZA_loop
    s_waitcnt vmcnt(0)
    s_barrier
    s_and_b32 s73, s66, 1
    s_mul_i32 s83, s61, 12288
    s_mul_i32 s74, s73, 6144
    s_add_u32 s83, s83, s74
    s_add_u32 s83, s83, 8978432
    s_mul_i32 s84, s61, 10240
    s_mul_i32 s74, s73, 1280
    s_add_u32 s84, s84, s74
    s_add_u32 s84, s84, 16941056
    s_add_u32 s74, s83, 0
    buffer_load_dwordx4 v[40:43], v1, s[4:7], s74 offen offset:0 sc1
    buffer_load_dwordx4 v[44:47], v1, s[4:7], s74 offen offset:1024 sc1
    buffer_load_dwordx4 v[48:51], v1, s[4:7], s74 offen offset:2048 sc1
    buffer_load_dwordx4 v[52:55], v1, s[4:7], s74 offen offset:3072 sc1
    s_add_u32 s74, s83, 4096
    buffer_load_dwordx4 v[56:59], v1, s[4:7], s74 offen offset:0 sc1
    buffer_load_dwordx4 v[60:63], v1, s[4:7], s74 offen offset:1024 sc1
    s_add_u32 s74, s83, 98304
    buffer_load_dwordx4 v[196:199], v1, s[4:7], s74 offen offset:0 sc1
    buffer_load_dwordx4 v[200:203], v1, s[4:7], s74 offen offset:1024 sc1
    buffer_load_dwordx4 v[204:207], v1, s[4:7], s74 offen offset:2048 sc1
    buffer_load_dwordx4 v[208:211], v1, s[4:7], s74 offen offset:3072 sc1
    s_add_u32 s74, s83, 102400
    buffer_load_dwordx4 v[64:67], v1, s[4:7], s74 offen offset:0 sc1
    buffer_load_dwordx4 v[68:71], v1, s[4:7], s74 offen offset:1024 sc1
    ds_read_b128 v[148:151], v11 offset:0
    ds_read_b128 v[152:155], v11 offset:2560
    ds_read_b128 v[156:159], v11 offset:5120
    ds_read_b128 v[160:163], v11 offset:7680
    ds_read_b32 v164, v12 offset:0
    ds_read_b32 v165, v12 offset:2560
    ds_read_b32 v166, v12 offset:5120
    ds_read_b32 v167, v12 offset:7680
    ds_read_b128 v[168:171], v9 offset:10240
    ds_read_b128 v[72:75], v9 offset:12288
    ds_read_b128 v[76:79], v9 offset:14336
    s_cmp_lg_u32 s66, 2
    s_cbranch_scc1 L_ZA_t0
    v_and_b32 v175, 0xffff0000, v173
    v_lshlrev_b32 v174, 16, v173
    v_and_b32 v173, 0xffff0000, v172
    v_lshlrev_b32 v172, 16, v172
    v_and_b32 v179, 0xffff0000, v177
    v_lshlrev_b32 v178, 16, v177
    v_and_b32 v177, 0xffff0000, v176
    v_lshlrev_b32 v176, 16, v176
    v_and_b32 v183, 0xffff0000, v181
    v_lshlrev_b32 v182, 16, v181
    v_and_b32 v181, 0xffff0000, v180
    v_lshlrev_b32 v180, 16, v180
    v_and_b32 v187, 0xffff0000, v185
    v_lshlrev_b32 v186, 16, v185
    v_and_b32 v185, 0xffff0000, v184
    v_lshlrev_b32 v184, 16, v184
    v_add_f32 v172, v172, v176
    v_add_f32 v180, v180, v184
    v_add_f32 v173, v173, v177
    v_add_f32 v181, v181, v185
    v_add_f32 v174, v174, v178
    v_add_f32 v182, v182, v186
    v_add_f32 v175, v175, v179
    v_add_f32 v183, v183, v187
    v_add_f32 v172, v172, v180
    v_add_f32 v173, v173, v181
    v_add_f32 v174, v174, v182
    v_add_f32 v175, v175, v183
    v_and_b32 v191, 0xffff0000, v190
    v_lshlrev_b32 v190, 16, v190
    v_permlane32_swap_b32 v172, v174
    v_permlane32_swap_b32 v173, v175
    v_add_f32 v172, v172, v174
    v_add_f32 v173, v173, v175
    v_add_f32 v172, v172, v190
    v_add_f32 v173, v173, v191
    v_cvt_pk_bf16_f32 v172, v172, v173
    buffer_store_dword v172, v193, s[16:19], s28 offen
L_ZA_t0:
    s_waitcnt lgkmcnt(0)
    v_mfma_f32_16x16x32_bf16 v[84:87], v[132:135], v[148:151], v[84:87]
    v_mfma_f32_16x16x32_bf16 v[84:87], v[136:139], v[152:155], v[84:87]
    v_mfma_f32_16x16x32_bf16 v[84:87], v[140:143], v[156:159], v[84:87]
    v_mfma_f32_16x16x32_bf16 v[84:87], v[144:147], v[160:163], v[84:87]
    v_mfma_f32_16x16x32_bf16 v[84:87], v[168:171], v[164:167], v[84:87]
    s_nop 7
    v_cvt_pk_bf16_f32 v212, v84, v85
    v_cvt_pk_bf16_f32 v213, v86, v87
    ds_bpermute_b32 v212, v14, v212
    ds_bpermute_b32 v213, v14, v213
    s_waitcnt lgkmcnt(0)
    s_waitcnt vmcnt(0)
    v_mfma_f32_16x16x32_bf16 v[88:91], v[16:19], v[40:43], 0
    v_mfma_f32_16x16x32_bf16 v[88:91], v[20:23], v[44:47], v[88:91]
    v_mfma_f32_16x16x32_bf16 v[88:91], v[24:27], v[48:51], v[88:91]
    v_mfma_f32_16x16x32_bf16 v[88:91], v[28:31], v[52:55], v[88:91]
    v_mfma_f32_16x16x32_bf16 v[88:91], v[32:35], v[56:59], v[88:91]
    v_mfma_f32_16x16x32_bf16 v[88:91], v[36:39], v[60:63], v[88:91]
    v_mfma_f32_16x16x32_bf16 v[92:95], v[16:19], v[196:199], 0
    v_mfma_f32_16x16x32_bf16 v[92:95], v[20:23], v[200:203], v[92:95]
    v_mfma_f32_16x16x32_bf16 v[92:95], v[24:27], v[204:207], v[92:95]
    v_mfma_f32_16x16x32_bf16 v[92:95], v[28:31], v[208:211], v[92:95]
    v_mfma_f32_16x16x32_bf16 v[92:95], v[32:35], v[64:67], v[92:95]
    v_mfma_f32_16x16x32_bf16 v[92:95], v[36:39], v[68:71], v[92:95]
    s_lshl_b32 s72, s61, 7
    s_add_u32 s72, s72, 5541888
    v_and_b32 v3, 7, v0
    v_lshlrev_b32 v3, 2, v3
    v_lshlrev_b32 v4, 2, v0
    buffer_load_dword v172, v3, s[4:7], s72 offen sc1
    s_nop 15
    buffer_load_dword v173, v3, s[4:7], s72 offen sc1
    s_nop 15
Lpoll_1079:
    buffer_load_dword v174, v3, s[4:7], s72 offen sc1
    s_waitcnt vmcnt(2)
    v_cmp_gt_i32 vcc, 1, v172
    s_cbranch_vccz Ldone_1080
    buffer_load_dword v172, v3, s[4:7], s72 offen sc1
    s_waitcnt vmcnt(2)
    v_cmp_gt_i32 vcc, 1, v173
    s_cbranch_vccz Ldone_1080
    buffer_load_dword v173, v3, s[4:7], s72 offen sc1
    s_waitcnt vmcnt(2)
    v_cmp_gt_i32 vcc, 1, v174
    s_cbranch_vccz Ldone_1080
    s_sub_u32 s65, s65, 1
    s_cbranch_scc0 Lpoll_1079
    s_mov_b32 s65, 0
Ldone_1080:
    s_add_u32 s74, s84, 0
    buffer_load_dwordx4 v[148:151], v1, s[4:7], s74 offen sc1
    buffer_load_dword v164, v4, s[4:7], s74 offen offset:1024 sc1
    s_add_u32 s74, s84, 2560
    buffer_load_dwordx4 v[152:155], v1, s[4:7], s74 offen sc1
    buffer_load_dword v165, v4, s[4:7], s74 offen offset:1024 sc1
    s_add_u32 s74, s84, 5120
    buffer_load_dwordx4 v[156:159], v1, s[4:7], s74 offen sc1
    buffer_load_dword v166, v4, s[4:7], s74 offen offset:1024 sc1
    s_add_u32 s74, s84, 7680
    buffer_load_dwordx4 v[160:163], v1, s[4:7], s74 offen sc1
    buffer_load_dword v167, v4, s[4:7], s74 offen offset:1024 sc1
    s_add_u32 s74, s84, 81920
    buffer_load_dwordx4 v[132:135], v1, s[4:7], s74 offen sc1
    buffer_load_dword v168, v4, s[4:7], s74 offen offset:1024 sc1
    s_add_u32 s74, s84, 84480
    buffer_load_dwordx4 v[136:139], v1, s[4:7], s74 offen sc1
    buffer_load_dword v169, v4, s[4:7], s74 offen offset:1024 sc1
    s_add_u32 s74, s84, 87040
    buffer_load_dwordx4 v[140:143], v1, s[4:7], s74 offen sc1
    buffer_load_dword v170, v4, s[4:7], s74 offen offset:1024 sc1
    s_add_u32 s74, s84, 89600
    buffer_load_dwordx4 v[144:147], v1, s[4:7], s74 offen sc1
    buffer_load_dword v171, v4, s[4:7], s74 offen offset:1024 sc1
    buffer_store_dwordx2 v[212:213], v7, s[4:7], s86 offen sc1
    s_waitcnt vmcnt(1)
    v_mfma_f32_16x16x32_bf16 v[88:91], v[116:119], v[148:151], v[88:91]
    v_mfma_f32_16x16x32_bf16 v[88:91], v[120:123], v[152:155], v[88:91]
    v_mfma_f32_16x16x32_bf16 v[88:91], v[124:127], v[156:159], v[88:91]
    v_mfma_f32_16x16x32_bf16 v[88:91], v[128:131], v[160:163], v[88:91]
    v_mfma_f32_16x16x32_bf16 v[88:91], v[72:75], v[164:167], v[88:91]
    v_mfma_f32_16x16x32_bf16 v[92:95], v[100:103], v[132:135], v[92:95]
    v_mfma_f32_16x16x32_bf16 v[92:95], v[104:107], v[136:139], v[92:95]
    v_mfma_f32_16x16x32_bf16 v[92:95], v[108:111], v[140:143], v[92:95]
    v_mfma_f32_16x16x32_bf16 v[92:95], v[112:115], v[144:147], v[92:95]
    v_mfma_f32_16x16x32_bf16 v[92:95], v[76:79], v[168:171], v[92:95]
    s_nop 2
    v_cvt_pk_bf16_f32 v88, v88, v89
    v_cvt_pk_bf16_f32 v89, v90, v91
    ds_bpermute_b32 v88, v14, v88
    ds_bpermute_b32 v89, v14, v89
    s_nop 0
    v_cvt_pk_bf16_f32 v92, v92, v93
    v_cvt_pk_bf16_f32 v93, v94, v95
    ds_bpermute_b32 v92, v14, v92
    ds_bpermute_b32 v93, v14, v93
    s_waitcnt lgkmcnt(0)
    s_add_u32 s86, s86, 327680
    buffer_store_dwordx2 v[88:89], v7, s[4:7], s86 offen sc1
    s_add_u32 s86, s86, 327680
    buffer_store_dwordx2 v[92:93], v7, s[4:7], s86 offen sc1
    s_lshl_b32 s72, s62, 10
    s_add_u32 s72, s72, 5542912
    s_lshl_b32 s73, s61, 7
    s_add_u32 s73, s73, s72
    v_mov_b32 v2, 1
    v_lshlrev_b32 v4, 7, v0
    s_cmp_lg_u32 s66, 0
    s_waitcnt vmcnt(0)
    s_barrier
    s_cbranch_scc1 L_ZA_tw
    s_mov_b64 exec, 1
    buffer_store_dword v2, off, s[4:7], s73 sc1
    s_mov_b64 exec, 0xff
    s_sleep 4
Ltd_1081:
    buffer_load_dword v2, v4, s[4:7], s72 offen sc1
    s_waitcnt vmcnt(0)
    v_cmp_gt_i32 vcc, 1, v2
    s_cbranch_vccz Ltdd_1082
    s_sub_u32 s65, s65, 1
    s_cbranch_scc0 Ltd_1081
Ltdd_1082:
    s_mov_b64 exec, -1
L_ZA_tw:
    s_barrier
    s_add_u32 s74, s66, 60
    s_mul_i32 s75, s74, 327680
    s_add_u32 s75, s75, 25165824
    s_mul_i32 s28, s74, 40960
    buffer_load_dword v190, v193, s[12:15], s28 offen
    buffer_load_dwordx2 v[172:173], v192, s[4:7], s75 offen sc1
    s_add_u32 s75, s75, 4096
    buffer_load_dwordx2 v[176:177], v192, s[4:7], s75 offen sc1
    s_add_u32 s75, s75, 4096
    buffer_load_dwordx2 v[180:181], v192, s[4:7], s75 offen sc1
    s_add_u32 s75, s75, 4096
    buffer_load_dwordx2 v[184:185], v192, s[4:7], s75 offen sc1
    s_cmp_lg_u32 s66, 0
    s_cbranch_scc1 L_ZA_t1
    s_mov_b32 s74, 59
    s_mul_i32 s75, s74, 327680
    s_add_u32 s75, s75, 25165824
    s_mul_i32 s83, s74, 40960
    buffer_load_dword v164, v193, s[12:15], s83 offen
    buffer_load_dwordx2 v[148:149], v192, s[4:7], s75 offen sc1
    s_add_u32 s75, s75, 4096
    buffer_load_dwordx2 v[152:153], v192, s[4:7], s75 offen sc1
    s_add_u32 s75, s75, 4096
    buffer_load_dwordx2 v[156:157], v192, s[4:7], s75 offen sc1
    s_add_u32 s75, s75, 4096
    buffer_load_dwordx2 v[160:161], v192, s[4:7], s75 offen sc1
    s_waitcnt vmcnt(0)
    v_and_b32 v151, 0xffff0000, v149
    v_lshlrev_b32 v150, 16, v149
    v_and_b32 v149, 0xffff0000, v148
    v_lshlrev_b32 v148, 16, v148
    v_and_b32 v155, 0xffff0000, v153
    v_lshlrev_b32 v154, 16, v153
    v_and_b32 v153, 0xffff0000, v152
    v_lshlrev_b32 v152, 16, v152
    v_and_b32 v159, 0xffff0000, v157
    v_lshlrev_b32 v158, 16, v157
    v_and_b32 v157, 0xffff0000, v156
    v_lshlrev_b32 v156, 16, v156
    v_and_b32 v163, 0xffff0000, v161
    v_lshlrev_b32 v162, 16, v161
    v_and_b32 v161, 0xffff0000, v160
    v_lshlrev_b32 v160, 16, v160
    v_add_f32 v148, v148, v152
    v_add_f32 v156, v156, v160
    v_add_f32 v149, v149, v153
    v_add_f32 v157, v157, v161
    v_add_f32 v150, v150, v154
    v_add_f32 v158, v158, v162
    v_add_f32 v151, v151, v155
    v_add_f32 v159, v159, v163
    v_add_f32 v148, v148, v156
    v_add_f32 v149, v149, v157
    v_add_f32 v150, v150, v158
    v_add_f32 v151, v151, v159
    v_and_b32 v165, 0xffff0000, v164
    v_lshlrev_b32 v164, 16, v164
    v_permlane32_swap_b32 v148, v150
    v_permlane32_swap_b32 v149, v151
    v_add_f32 v148, v148, v150
    v_add_f32 v149, v149, v151
    v_add_f32 v148, v148, v164
    v_add_f32 v149, v149, v165
    v_cvt_pk_bf16_f32 v148, v148, v149
    buffer_store_dword v148, v193, s[16:19], s83 offen
L_ZA_t1:
    s_waitcnt vmcnt(0)
    v_and_b32 v175, 0xffff0000, v173
    v_lshlrev_b32 v174, 16, v173
    v_and_b32 v173, 0xffff0000, v172
    v_lshlrev_b32 v172, 16, v172
    v_and_b32 v179, 0xffff0000, v177
    v_lshlrev_b32 v178, 16, v177
    v_and_b32 v177, 0xffff0000, v176
    v_lshlrev_b32 v176, 16, v176
    v_and_b32 v183, 0xffff0000, v181
    v_lshlrev_b32 v182, 16, v181
    v_and_b32 v181, 0xffff0000, v180
    v_lshlrev_b32 v180, 16, v180
    v_and_b32 v187, 0xffff0000, v185
    v_lshlrev_b32 v186, 16, v185
    v_and_b32 v185, 0xffff0000, v184
    v_lshlrev_b32 v184, 16, v184
    v_add_f32 v172, v172, v176
    v_add_f32 v180, v180, v184
    v_add_f32 v173, v173, v177
    v_add_f32 v181, v181, v185
    v_add_f32 v174, v174, v178
    v_add_f32 v182, v182, v186
    v_add_f32 v175, v175, v179
    v_add_f32 v183, v183, v187
    v_add_f32 v172, v172, v180
    v_add_f32 v173, v173, v181
    v_add_f32 v174, v174, v182
    v_add_f32 v175, v175, v183
    v_and_b32 v191, 0xffff0000, v190
    v_lshlrev_b32 v190, 16, v190
    v_permlane32_swap_b32 v172, v174
    v_permlane32_swap_b32 v173, v175
    v_add_f32 v172, v172, v174
    v_add_f32 v173, v173, v175
    v_add_f32 v172, v172, v190
    v_add_f32 v173, v173, v191
    v_cvt_pk_bf16_f32 v172, v172, v173
    buffer_store_dword v172, v193, s[16:19], s28 offen
L_end:
    s_endpgm
L_redo:
    s_mov_b32 s71, 1
    s_setprio 0
    s_cmp_lg_u32 s60, 0
    s_cbranch_scc1 L_role_wait
    s_mov_b32 s61, s78
    v_mov_b32 v3, 163584
    s_mov_b64 exec, 1
    s_cmp_gt_u32 s61, 7
    s_cbranch_scc1 L_surplus
    v_mov_b32 v1, 1
    s_lshl_b32 s72, s61, 5
    buffer_atomic_add v1, off, s[8:11], s72 sc0
    s_waitcnt vmcnt(0)
    v_readfirstlane_b32 s62, v1
    s_nop 0
    s_cmp_ge_u32 s62, 32
    s_cbranch_scc1 L_surplus
L_role_pub:
    s_mov_b64 exec, 1
    v_mov_b32 v4, s61
    v_mov_b32 v5, s62
    ds_write_b64 v3, v[4:5]
    s_mov_b64 exec, -1
L_role_wait:
    s_waitcnt vmcnt(0) lgkmcnt(0)
    s_barrier
    v_mov_b32 v8, 163584
    ds_read_b64 v[8:9], v8
    s_waitcnt lgkmcnt(0)
    v_readfirstlane_b32 s61, v8
    v_readfirstlane_b32 s62, v9
    s_and_b32 s61, s61, 7
    s_and_b32 s62, s62, 31
    s_branch L_dispatch
L_cal:
    s_cmp_lg_u32 s60, 0
    s_cbranch_scc1 L_cal_w
    s_mov_b64 exec, 1
    s_mov_b32 s73, -1
    s_mov_b32 s74, -1
    s_lshl_b32 s75, s61, 8
    s_add_u32 s75, s75, 5505024
    s_add_u32 s76, s75, 8192
    v_mov_b32 v2, 0
    s_memtime s[94:95]
    s_waitcnt lgkmcnt(0)
    buffer_atomic_add v2, off, s[4:7], s75 sc0
    s_waitcnt vmcnt(0)
    s_memtime s[96:97]
    s_waitcnt lgkmcnt(0)
    s_sub_u32 s72, s96, s94
    s_min_u32 s73, s73, s72
    v_mov_b32 v2, 0
    s_memtime s[94:95]
    s_waitcnt lgkmcnt(0)
    buffer_atomic_add v2, off, s[4:7], s76 sc0
    s_waitcnt vmcnt(0)
    s_memtime s[96:97]
    s_waitcnt lgkmcnt(0)
    s_sub_u32 s72, s96, s94
    s_min_u32 s74, s74, s72
    v_mov_b32 v2, 0
    s_memtime s[94:95]
    s_waitcnt lgkmcnt(0)
    buffer_atomic_add v2, off, s[4:7], s75 sc0
    s_waitcnt vmcnt(0)
    s_memtime s[96:97]
    s_waitcnt lgkmcnt(0)
    s_sub_u32 s72, s96, s94
    s_min_u32 s73, s73, s72
    v_mov_b32 v2, 0
    s_memtime s[94:95]
    s_waitcnt lgkmcnt(0)
    buffer_atomic_add v2, off, s[4:7], s76 sc0
    s_waitcnt vmcnt(0)
    s_memtime s[96:97]
    s_waitcnt lgkmcnt(0)
    s_sub_u32 s72, s96, s94
    s_min_u32 s74, s74, s72
    v_mov_b32 v2, 0
    s_memtime s[94:95]
    s_waitcnt lgkmcnt(0)
    buffer_atomic_add v2, off, s[4:7], s75 sc0
    s_waitcnt vmcnt(0)
    s_memtime s[96:97]
    s_waitcnt lgkmcnt(0)
    s_sub_u32 s72, s96, s94
    s_min_u32 s73, s73, s72
    v_mov_b32 v2, 0
    s_memtime s[94:95]
    s_waitcnt lgkmcnt(0)
    buffer_atomic_add v2, off, s[4:7], s76 sc0
    s_waitcnt vmcnt(0)
    s_memtime s[96:97]
    s_waitcnt lgkmcnt(0)
    s_sub_u32 s72, s96, s94
    s_min_u32 s74, s74, s72
    s_sub_u32 s72, s73, s74
    s_min_i32 s72, s72, 300
    s_max_i32 s72, s72, -300
    s_sub_u32 s73, 0, s72
    s_cmp_lt_u32 s61, 4
    s_cselect_b32 s72, s72, s73
    v_mov_b32 v2, s72
    buffer_atomic_add v2, off, s[8:11], 0 offset:20
    s_mov_b64 exec, -1
L_cal_w:
    s_barrier
    s_branch L_cal_done
L_surplus:
    v_mov_b32 v1, 1
    s_mov_b32 s72, 16
    buffer_atomic_add v1, off, s[8:11], s72 sc0
    s_waitcnt vmcnt(0)
    v_readfirstlane_b32 s73, v1
    s_mov_b64 exec, -1
    v_lshlrev_b32 v6, 4, v0
L_sur_poll:
    buffer_load_dword v7, v6, s[8:11], 0 offen sc1
    s_waitcnt vmcnt(0)
    v_readlane_b32 s74, v7, 1
    v_min_u32 v7, 32, v7
    s_nop 1
    v_readlane_b32 s75, v7, 0
    s_nop 0
    s_add_u32 s74, s74, s75
    v_readlane_b32 s75, v7, 2
    s_nop 0
    s_add_u32 s74, s74, s75
    v_readlane_b32 s75, v7, 4
    s_nop 0
    s_add_u32 s74, s74, s75
    v_readlane_b32 s75, v7, 6
    s_nop 0
    s_add_u32 s74, s74, s75
    v_readlane_b32 s75, v7, 8
    s_nop 0
    s_add_u32 s74, s74, s75
    v_readlane_b32 s75, v7, 10
    s_nop 0
    s_add_u32 s74, s74, s75
    v_readlane_b32 s75, v7, 12
    s_nop 0
    s_add_u32 s74, s74, s75
    v_readlane_b32 s75, v7, 14
    s_nop 0
    s_add_u32 s74, s74, s75
    s_cmp_ge_u32 s74, 256
    s_cbranch_scc1 L_sur_find
    s_sub_u32 s65, s65, 1
    s_cbranch_scc0 L_sur_poll
    s_mov_b32 s65, 0
L_sur_find:
    s_mov_b32 s61, 0
    s_mov_b32 s74, 0
L_sur_loop:
    s_nop 3
    v_readlane_b32 s75, v7, s74
    s_nop 0
    s_add_u32 s62, s75, s73
    s_cmp_lt_u32 s62, 32
    s_cbranch_scc1 L_role_pub
    s_sub_u32 s73, s62, 32
    s_add_u32 s61, s61, 1
    s_add_u32 s74, s74, 2
    s_cmp_lt_u32 s61, 8
    s_cbranch_scc1 L_sur_loop
    s_branch L_role_pub
Lgw_x_9:
    v_xor_b32 v3, 0x2000, v3
    v_lshrrev_b32 v3, 8, v3
    s_mov_b32 s74, 0
    v_readlane_b32 s75, v3, 0
    s_nop 0
    s_add_u32 s74, s74, s75
    v_readlane_b32 s75, v3, 1
    s_nop 0
    s_add_u32 s74, s74, s75
    v_readlane_b32 s75, v3, 2
    s_nop 0
    s_add_u32 s74, s74, s75
    v_readlane_b32 s75, v3, 3
    s_nop 0
    s_add_u32 s74, s74, s75
    v_readlane_b32 s75, v3, 4
    s_nop 0
    s_add_u32 s74, s74, s75
    v_readlane_b32 s75, v3, 5
    s_nop 0
    s_add_u32 s74, s74, s75
    v_readlane_b32 s75, v3, 6
    s_nop 0
    s_add_u32 s74, s74, s75
    v_readlane_b32 s75, v3, 7
    s_nop 0
    s_add_u32 s74, s74, s75
    v_mov_b32 v2, -1
    s_cmp_ge_u32 s74, 256
    s_cbranch_scc1 Lgw_r_10
    s_sleep 8
    s_sub_u32 s65, s65, 1
    s_cbranch_scc0 Lgw_6
    s_mov_b32 s65, 0
    s_branch Lgw_done_7
Lgw_m1_8:
    buffer_load_dword v2, v4, s[8:11], 0 offen sc1
    buffer_load_dword v3, off, s[8:11], s73 sc1
    s_waitcnt vmcnt(0)
    v_min_u32 v2, 32, v2
    v_readfirstlane_b32 s74, v3
    v_readlane_b32 s75, v2, 0
    s_nop 0
    s_add_u32 s74, s74, s75
    v_readlane_b32 s75, v2, 1
    s_nop 0
    s_add_u32 s74, s74, s75
    v_readlane_b32 s75, v2, 2
    s_nop 0
    s_add_u32 s74, s74, s75
    v_readlane_b32 s75, v2, 3
    s_nop 0
    s_add_u32 s74, s74, s75
    v_readlane_b32 s75, v2, 4
    s_nop 0
    s_add_u32 s74, s74, s75
    v_readlane_b32 s75, v2, 5
    s_nop 0
    s_add_u32 s74, s74, s75
    v_readlane_b32 s75, v2, 6
    s_nop 0
    s_add_u32 s74, s74, s75
    v_readlane_b32 s75, v2, 7
    s_nop 0
    s_add_u32 s74, s74, s75
    s_cmp_ge_u32 s74, 256
    s_cbranch_scc1 Lgw_done_7
    s_sleep 8
    s_sub_u32 s65, s65, 1
    s_cbranch_scc0 Lgw_m1_8
    s_mov_b32 s65, 0
    s_branch Lgw_done_7
Lslow_17:
    buffer_store_dwordx2 v[124:125], v135, s[4:7], s83 offen sc1
    s_nop 1
    s_branch Lback_18
Lslow_23:
    buffer_store_dword v52, v9, s[4:7], s85 offen sc1
    s_nop 1
    s_branch Lback_24
Lslow_25:
    buffer_store_dwordx2 v[52:53], v135, s[4:7], s74 offen sc1
    s_nop 1
    s_branch Lback_26
Lslow_27:
    buffer_store_dword v48, v9, s[4:7], s84 offen sc1
    s_nop 1
    s_branch Lback_28
Lslow_33:
    buffer_store_dwordx4 v[52:55], v1, s[4:7], s74 offen offset:0 sc1
    buffer_store_dwordx4 v[52:55], v1, s[4:7], s74 offen offset:1024 sc1
    buffer_store_dwordx4 v[52:55], v1, s[4:7], s74 offen offset:2048 sc1
    buffer_store_dwordx4 v[52:55], v1, s[4:7], s74 offen offset:3072 sc1
    buffer_store_dwordx4 v[52:55], v1, s[4:7], s75 offen sc1
    s_nop 1
    s_branch Lback_34
Lslow_35:
    buffer_store_dword v52, v9, s[4:7], s85 offen sc1
    s_nop 1
    s_branch Lback_36
Lslow_37:
    buffer_store_dword v48, v9, s[4:7], s84 offen sc1
    s_nop 1
    s_branch Lback_38
Lslow_39:
    buffer_store_dwordx4 v[92:95], v1, s[4:7], s83 offen sc1
    buffer_store_dwordx4 v[96:99], v1, s[4:7], s83 offen offset:1024 sc1
    buffer_store_dwordx2 v[100:101], v11, s[4:7], s83 offen offset:2048 sc1
    s_nop 1
    s_branch Lback_40
Lretry_42:
    s_sub_u32 s65, s65, 1
    s_cbranch_scc0 Lpoll_41
    s_mov_b32 s65, 0
    s_branch Ldone_43
Lslow_44:
    buffer_store_dwordx4 v[80:83], v1, s[4:7], s74 offen sc1
    buffer_store_dword v84, v12, s[4:7], s74 offen offset:1024 sc1
    s_nop 1
    s_branch Lback_45
Lslow_46:
    buffer_store_dwordx2 v[88:89], v1, s[4:7], s74 offen sc1
    s_nop 1
    s_branch Lback_47
Lretry_49:
    s_sub_u32 s65, s65, 1
    s_cbranch_scc0 Lpoll_48
    s_mov_b32 s65, 0
    s_branch Ldone_50
Lslow_51:
    buffer_store_dwordx4 v[80:83], v1, s[4:7], s74 offen sc1
    buffer_store_dword v84, v12, s[4:7], s74 offen offset:1024 sc1
    s_nop 1
    s_branch Lback_52
Lslow_53:
    buffer_store_dword v2, off, s[4:7], s72 sc1
    s_nop 1
    s_branch Lback_54
Lslow_61:
    buffer_store_dword v6, v253, s[4:7], s85 offen sc1
    s_nop 1
    s_branch Lback_62
Lslow_1064:
    buffer_store_dword v6, v253, s[4:7], s85 offen sc1
    s_nop 1
    s_branch Lback_1065
Lpf_58:
    buffer_load_dwordx4 v[224:227], v1, s[4:7], s83 offen sc1
    buffer_load_dwordx4 v[228:231], v199, s[4:7], s83 offen offset:1024 sc1
    s_waitcnt vmcnt(2)
    v_mfma_f32_16x16x32_bf16 v[220:223], v[236:239], v[248:251], 0
    v_mfma_f32_16x16x32_bf16 v[216:219], v[232:235], v[176:179], 0
    v_mfma_f32_16x16x32_bf16 v[216:219], v[236:239], v[180:183], v[216:219]
    v_max3_u32 v7, v232, v233, v234
    v_max3_u32 v7, v7, v235, v236
    v_max3_u32 v7, v7, v237, v238
    v_max_u32 v7, v7, v239
    v_cmp_eq_u32 vcc, -1, v7
    s_cbranch_vccnz Lpf_63
    buffer_store_dword v6, v253, s[4:7], s85 offen
    ds_write_b32 v252, v6
    v_add_f32 v220, v220, v222
    v_add_f32 v221, v221, v223
    v_max3_f32 v223, v216, v217, v218
    v_cndmask_b32 v220, v220, v221, s[92:93]
    v_max3_f32 v223, v223, v219, v220
    s_cmp_lg_u32 s63, 0
    s_cbranch_scc1 Lslow_1064
Lback_1065:
    v_max_f32_dpp v223, v223, v223 quad_perm:[1,0,3,2] row_mask:0xf bank_mask:0xf
    v_mov_b32 v222, v223
    s_nop 1
    v_permlane16_swap_b32 v223, v222
    v_max_f32 v223, v223, v222
    v_mov_b32 v222, v223
    s_nop 1
    v_permlane32_swap_b32 v223, v222
    v_max_f32 v223, v223, v222
    v_sub_f32 v216, v216, v223
    v_sub_f32 v217, v217, v223
    v_sub_f32 v218, v218, v223
    v_sub_f32 v219, v219, v223
    v_sub_f32 v220, v220, v223
    v_exp_f32 v220, v220
    v_exp_f32 v216, v216
    v_exp_f32 v217, v217
    v_exp_f32 v218, v218
    v_exp_f32 v219, v219
    v_mov_b32_dpp v221, v220 quad_perm:[1,0,3,2] row_mask:0xf bank_mask:0xf
    v_cvt_pk_bf16_f32 v200, v216, v217
    v_cvt_pk_bf16_f32 v201, v218, v219
    v_cvt_pk_bf16_f32 v194, v220, v221
    v_mov_b32_dpp v202, v200 quad_perm:[1,0,3,2] row_mask:0xf bank_mask:0xf
    v_mov_b32_dpp v203, v201 quad_perm:[1,0,3,2] row_mask:0xf bank_mask:0xf
    v_mfma_f32_16x16x32_bf16 v[212:215], v[188:191], v[194:197], 0
    v_mfma_f32_16x16x32_bf16 v[204:207], v[184:187], v[194:197], 0
    v_mfma_f32_16x16x32_bf16 v[208:211], v[184:187], v[192:195], 0
    v_mfma_f32_16x16x32_bf16 v[212:215], v[188:191], v[200:203], v[212:215]
    v_mfma_f32_16x16x32_bf16 v[204:207], v[168:171], v[200:203], v[204:207]
    v_mfma_f32_16x16x32_bf16 v[208:211], v[172:175], v[200:203], v[208:211]
    s_nop 5
    v_rcp_f32 v223, v212
    s_nop 0
    v_cndmask_b32 v204, v204, v208, s[92:93]
    v_cndmask_b32 v205, v205, v209, s[92:93]
    v_cndmask_b32 v206, v206, v210, s[92:93]
    v_cndmask_b32 v207, v207, v211, s[92:93]
    v_mul_f32 v204, v204, v223
    v_mul_f32 v205, v205, v223
    v_mul_f32 v206, v206, v223
    v_mul_f32 v207, v207, v223
    ds_write_b128 v5, v[204:207]
    s_waitcnt lgkmcnt(0)
    s_barrier
    s_branch Ljoin_59
Lpf_63:
    s_sub_u32 s65, s65, 1
    s_cbranch_scc0 Lpoll_57
    s_mov_b32 s65, 0
    s_nop 7
    s_branch Ltail_60
Lgw_x_1070:
    v_xor_b32 v3, 0x2000, v3
    v_lshrrev_b32 v3, 8, v3
    s_mov_b32 s74, 0
    v_readlane_b32 s75, v3, 0
    s_nop 0
    s_add_u32 s74, s74, s75
    v_readlane_b32 s75, v3, 1
    s_nop 0
    s_add_u32 s74, s74, s75
    v_readlane_b32 s75, v3, 2
    s_nop 0
    s_add_u32 s74, s74, s75
    v_readlane_b32 s75, v3, 3
    s_nop 0
    s_add_u32 s74, s74, s75
    v_readlane_b32 s75, v3, 4
    s_nop 0
    s_add_u32 s74, s74, s75
    v_readlane_b32 s75, v3, 5
    s_nop 0
    s_add_u32 s74, s74, s75
    v_readlane_b32 s75, v3, 6
    s_nop 0
    s_add_u32 s74, s74, s75
    v_readlane_b32 s75, v3, 7
    s_nop 0
    s_add_u32 s74, s74, s75
    v_mov_b32 v2, -1
    s_cmp_ge_u32 s74, 256
    s_cbranch_scc1 Lgw_r_1071
    s_sleep 8
    s_sub_u32 s65, s65, 1
    s_cbranch_scc0 Lgw_1067
    s_mov_b32 s65, 0
    s_branch Lgw_done_1068
Lgw_m1_1069:
    buffer_load_dword v2, v4, s[8:11], 0 offen sc1
    buffer_load_dword v3, off, s[8:11], s73 sc1
    s_waitcnt vmcnt(0)
    v_min_u32 v2, 32, v2
    v_readfirstlane_b32 s74, v3
    v_readlane_b32 s75, v2, 0
    s_nop 0
    s_add_u32 s74, s74, s75
    v_readlane_b32 s75, v2, 1
    s_nop 0
    s_add_u32 s74, s74, s75
    v_readlane_b32 s75, v2, 2
    s_nop 0
    s_add_u32 s74, s74, s75
    v_readlane_b32 s75, v2, 3
    s_nop 0
    s_add_u32 s74, s74, s75
    v_readlane_b32 s75, v2, 4
    s_nop 0
    s_add_u32 s74, s74, s75
    v_readlane_b32 s75, v2, 5
    s_nop 0
    s_add_u32 s74, s74, s75
    v_readlane_b32 s75, v2, 6
    s_nop 0
    s_add_u32 s74, s74, s75
    v_readlane_b32 s75, v2, 7
    s_nop 0
    s_add_u32 s74, s74, s75
    s_cmp_ge_u32 s74, 256
    s_cbranch_scc1 Lgw_done_1068
    s_sleep 8
    s_sub_u32 s65, s65, 1
    s_cbranch_scc0 Lgw_m1_1069
    s_mov_b32 s65, 0
    s_branch Lgw_done_1068
Lretry_1075:
    s_sub_u32 s65, s65, 1
    s_cbranch_scc0 Lpoll_1074
    s_mov_b32 s65, 0
    s_branch Ldone_1076
    s_endpgm
.section .rodata,"a"
.p2align 6
.amdhsa_kernel parallel_sum__memory_aug_recurrent_mem_tr__dense_activation_silu__prompt_kernel
  .amdhsa_next_free_vgpr 256
  .amdhsa_next_free_sgpr 102
  .amdhsa_accum_offset 256
  .amdhsa_group_segment_fixed_size 0
  .amdhsa_kernarg_size 104
  .amdhsa_user_sgpr_count 2
  .amdhsa_user_sgpr_kernarg_segment_ptr 1
  .amdhsa_system_sgpr_workgroup_id_x 1
  .amdhsa_float_denorm_mode_32 3
.end_amdhsa_kernel
```
